```python
import torch

def _softmax(x, axis=-1):
    return torch.softmax(x, dim=axis)
def _gelu(x):
    return torch.nn.functional.gelu(x, approximate="tanh")
def _silu(x):
    return torch.nn.functional.silu(x)
def _sigmoid(x):
    return torch.sigmoid(x)
def _layernorm(x, axis=-1, eps=1e-5):
    m = x.mean(dim=axis, keepdim=True)
    v = x.var(dim=axis, keepdim=True, unbiased=False)
    return (x - m) / torch.sqrt(v + eps)
def _scatter_add(tgt, idx, src, axis=0):
    return tgt.clone().index_add_(axis, idx, src)
def _segment_sum(src, seg, n):
    out = torch.zeros((n,) + src.shape[1:], dtype=src.dtype)
    return out.index_add_(0, seg, src)
def _pad(x, pw):
    flat = tuple(v for pair in reversed(pw) for v in pair)
    return torch.nn.functional.pad(x, flat)

kernel_name = 'concat_heads__mha_block__softmax_full_mha__prompt'

def setup_inputs():

    _w = (lambda a: (lambda t: t.to(torch.bfloat16) if t.is_floating_point() else t)(torch.as_tensor(a)))
    def _A_setup():
        B, S, D, H = 1, 2048, 640, 32
        return {
            "x": _w((lambda *s: torch.randn(*s, dtype=torch.bfloat16) * 0.2)(B, S, D)),
            "wqkv": _w((lambda *s: torch.randn(*s, dtype=torch.bfloat16) * 0.2)(D, 3 * D)),
            "wo": _w((lambda *s: torch.randn(*s, dtype=torch.bfloat16) * 0.05)(D, D)),
        }
    _A_in = _A_setup()

    def _B_setup():
        B, S, D = 1, 2048, 640
        return {
            "x": _w((lambda *s: torch.randn(*s, dtype=torch.bfloat16) * 0.2)(B, S, D)),
            "wqkv": _w((lambda *s: torch.randn(*s, dtype=torch.bfloat16) * 0.2)(D, 3 * D)),
            "wo": _w((lambda *s: torch.randn(*s, dtype=torch.bfloat16) * 0.05)(D, D)),
        }
    _B_in = _B_setup()

    return {
        "A_x": _A_in["x"],
        "A_wqkv": _A_in["wqkv"],
        "A_wo": _A_in["wo"],
        "B_x": _B_in["x"],
        "B_wqkv": _B_in["wqkv"],
        "B_wo": _B_in["wo"],
    }

def reference(A_x, A_wqkv, A_wo, B_x, B_wqkv, B_wo):
    def _A_ref(x, wqkv, wo):
        B, S, D = x.shape
        H = 32
        Dh = D // H
        qkv = (lambda x, *d: x.permute(*d))((x @ wqkv).reshape(B, S, 3, H, Dh), 2, 0, 3, 1, 4)
        q, k, v = qkv[0], qkv[1], qkv[2]
        scores = torch.einsum("bhqd,bhkd->bhqk", q, k) * (Dh ** -0.5)
        p = _softmax(scores, axis=-1)
        o = torch.einsum("bhqk,bhkd->bhqd", p, v)
        return (lambda x, *d: x.permute(*d))(o, 0, 2, 1, 3).reshape(B, S, D) @ wo

    def _B_ref(x, wqkv, wo):
        B, S, D = x.shape
        H = 32; Dh = D // H
        qkv = (lambda x, *d: x.permute(*d))((x @ wqkv).reshape(B, S, 3, H, Dh), 2, 0, 3, 1, 4)
        q, k, v = qkv[0], qkv[1], qkv[2]
        scale = Dh ** -0.5
        scores = torch.einsum("bhqd,bhkd->bhqk", q, k) * scale
        p = _softmax(scores, axis=-1)
        o = torch.einsum("bhqk,bhkd->bhqd", p, v)
        return (lambda x, *d: x.permute(*d))(o, 0, 2, 1, 3).reshape(B, S, D) @ wo

    a = _A_ref(A_x, A_wqkv, A_wo)
    b = _B_ref(B_x, B_wqkv, B_wo)
    return torch.concatenate([a, b], axis=-1)
```

```asm
; @launch grid=(256,1,1) block=(512,1,1) lds=163840
.amdgcn_target "amdgcn-amd-amdhsa--gfx950"
.text
.globl concat_heads__mha_block__softmax_full_mha__prompt_kernel
.p2align 8
.type concat_heads__mha_block__softmax_full_mha__prompt_kernel,@function
concat_heads__mha_block__softmax_full_mha__prompt_kernel:
    s_cmp_ge_u32 s2, 256
    s_cbranch_scc1 L_end
    s_bfe_u32 s22, s2, 0x10002
    s_mul_i32 s30, s22, 24
    s_load_dwordx4 s[4:7], s[0:1], s30
    v_lshrrev_b32 v4, 6, v0
    v_and_b32 v1, 63, v0
    v_readfirstlane_b32 s26, v4
    s_bfe_u32 s23, s2, 0x10001
    s_lshl_b32 s23, s23, 2
    s_bfe_u32 s30, s2, 0x20003
    s_or_b32 s23, s23, s30
    s_lshr_b32 s25, s2, 1
    s_xor_b32 s25, s25, s2
    s_and_b32 s25, s25, 1
    s_lshl_b32 s24, s25, 3
    s_lshr_b32 s30, s2, 5
    s_or_b32 s24, s24, s30
    s_lshr_b32 s30, s2, 7
    s_xor_b32 s24, s24, s30
    s_and_b32 s27, s26, 1
    v_lshrrev_b32 v4, 3, v0
    s_mul_i32 s30, s26, 24
    v_add_u32 v4, s30, v4
    v_mul_u32_u24 v4, 1280, v4
    v_lshrrev_b32 v7, 4, v1
    v_and_b32 v6, 7, v1
    v_xor_b32 v5, v7, v6
    v_xor_b32 v6, 4, v5
    v_lshl_add_u32 v80, v5, 4, v4
    v_lshl_add_u32 v81, v6, 4, v4
    v_add_u32 v81, 9216, v81
    v_add_u32 v82, 18432, v80
    v_add_u32 v83, 18432, v81
    s_lshr_b32 s30, s26, 1
    s_mul_i32 s35, s30, 24576
    s_lshl_b32 s30, s27, 12
    s_add_u32 s35, s35, s30
    s_mov_b32 s14, 327680
    s_mov_b32 s15, 0x20000
    s_xor_b32 s30, s23, s24
    s_and_b32 s30, s30, 1
    s_mul_i32 s30, s30, 5
    s_xor_b32 s31, s2, 1
    s_and_b32 s31, s31, 1
    s_mul_i32 s31, s31, 2
    s_add_u32 s30, s30, s31
    s_bfe_u32 s31, s2, 0x10005
    s_mul_i32 s31, s31, 9
    s_add_u32 s30, s30, s31
    s_cmp_ge_u32 s30, 10
    s_cselect_b32 s31, 10, 0
    s_sub_u32 s30, s30, s31
    s_lshl_b32 s33, s30, 7
    s_mul_i32 s34, s30, 245760
    s_mul_i32 s30, s23, 327680
    s_waitcnt lgkmcnt(0)
    s_add_u32 s12, s4, s30
    s_addc_u32 s13, s5, 0
    s_add_u32 m0, s35, 0
    s_nop 0
    buffer_load_dwordx4 v80, s[12:15], s33 offen offset:0 lds
    buffer_load_dwordx4 v81, s[12:15], s33 offen offset:1024 lds
    buffer_load_dwordx4 v82, s[12:15], s33 offen offset:2048 lds
    buffer_load_dwordx4 v83, s[12:15], s33 offen offset:3072 lds
    s_load_dwordx2 s[8:9], s[0:1], 64
    s_load_dwordx2 s[44:45], s[0:1], 56
    s_mul_i32 s30, s22, 24
    s_add_u32 s30, s30, 16
    s_load_dwordx2 s[56:57], s[0:1], s30
    s_load_dwordx2 s[58:59], s[0:1], 48
    s_memrealtime s[20:21]
L_pfbase0:
    s_getpc_b64 s[48:49]
    s_and_b32 s30, s2, -8
    s_add_u32 s30, s30, s26
    s_lshl_b32 s30, s30, 7
    s_min_u32 s30, s30, L_code_end-L_pfbase0-8
    v_mov_b32 v254, s30
    global_load_dword v254, v254, s[48:49]
    s_lshl_b32 s30, s27, 3
    v_lshl_add_u32 v5, v7, 1, s30
    v_and_b32 v2, 15, v1
    v_xor_b32 v5, v5, v2
    v_lshlrev_b32 v5, 2, v5
    s_mov_b32 s46, 0x96854130
    s_mov_b32 s47, 0xfcedba72
    v_lshrrev_b64 v[16:17], v5, s[46:47]
    v_and_b32 v5, 15, v16
    s_lshl_b32 s30, s26, 3
    v_add_u32 v4, s30, v7
    v_mul_u32_u24 v4, 3840, v4
    v_mul_u32_u24 v6, 13, v5
    v_lshrrev_b32 v6, 6, v6
    v_mul_u32_u24 v6, 1200, v6
    v_cmp_eq_u32 vcc, 15, v5
    v_lshl_add_u32 v5, v5, 4, v6
    v_mov_b32 v15, 0x40000000
    s_and_b32 s30, s24, 7
    s_mov_b32 s31, 0x40000000
    s_cmp_eq_u32 s30, 0
    s_cselect_b32 s31, 256, s31
    s_cmp_eq_u32 s30, 2
    s_cselect_b32 s31, 1376, s31
    s_cmp_eq_u32 s30, 5
    s_cselect_b32 s31, 2416, s31
    s_bfe_u32 s30, s23, 0x10001
    v_lshrrev_b32 v6, 1, v7
    v_cmp_eq_u32 s[46:47], s30, v6
    v_mov_b32 v6, s31
    s_nop 0
    v_cndmask_b32 v6, v15, v6, s[46:47]
    v_cndmask_b32 v5, v5, v6, vcc
    v_add_u32 v84, v4, v5
    v_add_u32 v85, 14336, v84
    s_lshl_b32 s36, s26, 11
    s_add_u32 s36, s36, 98304
    s_mov_b32 s19, 0x20000
    s_mul_i32 s31, s24, 80
    s_sub_u32 s18, 2457600, s31
    s_add_u32 s16, s6, s31
    s_addc_u32 s17, s7, 0
    s_add_u32 m0, s36, 0
    s_add_u32 s33, s33, 128
    buffer_load_dwordx4 v84, s[16:19], s34 offen offset:0 lds
    buffer_load_dwordx4 v85, s[16:19], s34 offen offset:1024 lds
    s_add_u32 s34, s34, 245760
    s_cmp_eq_u32 s33, 1280
    s_cselect_b32 s33, 0, s33
    s_cselect_b32 s34, 0, s34
    s_bfe_u32 s28, s26, 0x10001
    s_lshr_b32 s29, s26, 2
    s_mov_b32 s10, 20021248
    s_mov_b32 s11, 0x20000
    s_and_b32 s32, s26, 3
    v_lshrrev_b32 v4, 1, v2
    v_xor_b32 v4, v4, v7
    s_mul_i32 s30, s32, 24576
    v_lshl_add_u32 v5, v2, 7, s30
    v_lshl_add_u32 v86, v4, 4, v5
    v_xor_b32 v87, 64, v86
    v_bfe_u32 v4, v1, 2, 2
    v_lshl_add_u32 v5, v7, 3, v4
    v_lshlrev_b32 v5, 8, v5
    v_and_b32 v6, 3, v1
    v_lshl_add_u32 v5, v6, 3, v5
    v_add_u32 v5, 98304, v5
    v_bfe_u32 v4, v1, 2, 3
    s_lshl_b32 s30, s29, 2
    v_xor_b32 v4, s30, v4
    v_lshl_add_u32 v88, v4, 5, v5
    v_xor_b32 v89, 32, v88
    v_xor_b32 v90, 64, v88
    v_xor_b32 v91, 96, v88
    v_lshlrev_b32 v13, 4, v1
    s_lshl_b32 s30, s32, 14
    s_add_u32 s30, s30, 1024
    v_add_u32 v245, s30, v13
    v_cmp_lt_u32 vcc, 1, v7
    v_lshlrev_b32 v4, 3, v1
    v_add_u32 v4, 4096, v4
    v_mov_b32 v5, 0x3ea52b5c
    v_cndmask_b32 v243, v15, v4, vcc
    v_cndmask_b32 v248, v5, 1.0, vcc
    v_and_b32 v4, 4, v2
    v_and_b32 v5, 8, v2
    v_lshlrev_b32 v4, 5, v4
    v_lshl_add_u32 v4, v5, 3, v4
    v_and_b32 v5, 0x330, v13
    v_add_u32 v4, v4, v5
    v_add_u32 v244, 6144, v4
    v_add_u32 v246, s30, v244
    v_and_b32 v4, 11, v2
    v_cmp_eq_u32 vcc, 8, v4
    v_mov_b32 v4, 0x3f803f80
    v_and_b32 v2, 31, v0
    v_cndmask_b32 v249, 0, v4, vcc
    v_bfe_u32 v3, v0, 5, 1
    v_mov_b32 v156, 0
    v_mov_b32 v157, 0
    v_mov_b32 v158, 0
    v_mov_b32 v159, 0
    v_mov_b32 v160, 0
    v_mov_b32 v161, 0
    v_mov_b32 v162, 0
    v_mov_b32 v163, 0
    v_mov_b32 v164, 0
    v_mov_b32 v165, 0
    v_mov_b32 v166, 0
    v_mov_b32 v167, 0
    v_mov_b32 v168, 0
    v_mov_b32 v169, 0
    v_mov_b32 v170, 0
    v_mov_b32 v171, 0
    v_mov_b32 v172, 0
    v_mov_b32 v173, 0
    v_mov_b32 v174, 0
    v_mov_b32 v175, 0
    v_mov_b32 v176, 0
    v_mov_b32 v177, 0
    v_mov_b32 v178, 0
    v_mov_b32 v179, 0
    v_mov_b32 v180, 0
    v_mov_b32 v181, 0
    v_mov_b32 v182, 0
    v_mov_b32 v183, 0
    v_mov_b32 v184, 0
    v_mov_b32 v185, 0
    v_mov_b32 v186, 0
    v_mov_b32 v187, 0
    v_mov_b32 v188, 0
    v_mov_b32 v189, 0
    v_mov_b32 v190, 0
    v_mov_b32 v191, 0
    v_mov_b32 v192, 0
    v_mov_b32 v193, 0
    v_mov_b32 v194, 0
    v_mov_b32 v195, 0
    v_mov_b32 v196, 0
    v_mov_b32 v197, 0
    v_mov_b32 v198, 0
    v_mov_b32 v199, 0
    v_mov_b32 v200, 0
    v_mov_b32 v201, 0
    v_mov_b32 v202, 0
    v_mov_b32 v203, 0
    v_mov_b32 v204, 0
    v_mov_b32 v205, 0
    v_mov_b32 v206, 0
    v_mov_b32 v207, 0
    v_mov_b32 v208, 0
    v_mov_b32 v209, 0
    v_mov_b32 v210, 0
    v_mov_b32 v211, 0
    v_mov_b32 v212, 0
    v_mov_b32 v213, 0
    v_mov_b32 v214, 0
    v_mov_b32 v215, 0
    v_mov_b32 v216, 0
    v_mov_b32 v217, 0
    v_mov_b32 v218, 0
    v_mov_b32 v219, 0
    v_mov_b32 v220, 0
    v_mov_b32 v221, 0
    v_mov_b32 v222, 0
    v_mov_b32 v223, 0
    v_mov_b32 v224, 0
    v_mov_b32 v225, 0
    v_mov_b32 v226, 0
    v_mov_b32 v227, 0
    v_mov_b32 v228, 0
    v_mov_b32 v229, 0
    v_mov_b32 v230, 0
    v_mov_b32 v231, 0
    v_mov_b32 v232, 0
    v_mov_b32 v233, 0
    v_mov_b32 v234, 0
    v_mov_b32 v235, 0
    v_mov_b32 v236, 0
    v_mov_b32 v237, 0
    v_mov_b32 v238, 0
    v_mov_b32 v239, 0
    v_mov_b32 v240, 0
    v_mov_b32 v241, 0
    v_mov_b32 v242, 0
    v_mov_b32 v11, 0xdddddddd
    v_and_b32 v4, 4, v2
    v_lshlrev_b32 v4, 8, v4
    v_and_b32 v5, 24, v2
    v_lshl_add_u32 v4, v5, 3, v4
    v_and_b32 v5, 3, v2
    v_lshl_add_u32 v4, v5, 4, v4
    s_lshl_b32 s30, s29, 9
    v_lshl_add_u32 v5, v3, 8, s30
    v_add_u32 v8, v4, v5
    s_lshl_b32 s46, s32, 14
    v_add_u32 v247, s46, v8
    s_lshl_b32 s30, s29, 8
    s_add_u32 s30, s30, s46
    v_add_u32 v250, s30, v4
    s_lshl_b32 s30, s29, 7
    s_add_u32 s30, s30, 4352
    v_lshrrev_b32 v4, 1, v4
    v_cmp_eq_u32 vcc, 0, v3
    v_add_u32 v4, s30, v4
    v_add_u32 v6, 2048, v13
    v_mov_b32 v9, v4
    v_cndmask_b32 v14, v15, v6, vcc
    v_lshlrev_b32 v5, 3, v1
    v_lshl_or_b32 v12, v7, 29, v5
    v_min_u32 v4, 21, v2
    v_lshlrev_b32 v4, 4, v4
    v_lshl_add_u32 v4, v3, 8, v4
    s_lshl_b32 s30, s29, 10
    s_add_u32 s30, s30, 6144
    s_lshl_b32 s31, s29, 7
    s_add_u32 s31, s31, 7936
    v_cmp_gt_u32 vcc, 16, v2
    v_add_u32 v5, s30, v4
    v_add_u32 v6, s31, v4
    v_cndmask_b32 v4, v6, v5, vcc
    v_cmp_gt_u32 vcc, 21, v2
    v_add_u32 v251, s46, v4
    s_lshl_b32 s30, s23, 2
    v_cndmask_b32 v10, v15, v4, vcc
    s_add_u32 s30, s30, s32
    s_lshl_b32 s46, s22, 5
    s_add_u32 s31, s30, s46
    s_lshl_b32 s31, s31, 1
    s_add_u32 s31, s31, s29
    s_lshl_b32 s53, s31, 4
    s_add_u32 s53, s53, s24
    s_mul_i32 s31, s31, 8576
    s_lshl_b32 s54, s24, 3
    s_add_u32 s31, s31, s54
    s_add_u32 s54, s31, 18923520
    s_mul_i32 s53, s53, 2560
    s_add_u32 s53, s53, 12582912
    s_lshl_b32 s46, s22, 4
    s_add_u32 s46, s46, s24
    s_mul_i32 s50, s46, 393216
    s_mul_i32 s51, s30, 12288
    s_add_u32 s51, s51, s50
    s_mul_i32 s31, s32, 12288
    s_add_u32 s50, s50, s31
    s_lshl_b32 s46, s46, 2
    s_add_u32 s46, s46, s32
    s_mul_i32 s46, s46, 8576
    s_add_u32 s52, s46, 17825792
    s_and_b32 s30, s23, 4
    s_lshl_b32 s30, s30, 1
    s_lshl_b32 s55, 0xff, s30
    s_mul_i32 s30, s32, 12288
    s_add_u32 s30, s30, 103424
    v_add_u32 v15, s30, v13
    s_lshl_b32 s30, s26, 5
    v_mov_b32 v3, s30
    s_cmp_ge_u32 s26, 5
    s_cselect_b64 vcc, -1, 0
    s_cselect_b32 s31, 1, 0
    s_lshl_b32 s30, s26, s31
    s_mul_i32 s46, s31, 10
    s_sub_u32 s30, s30, s46
    s_add_u32 s31, s31, s30
    s_min_u32 s31, s31, 4
    s_lshl_b32 s46, s30, 6
    v_add_u32 v4, s46, v1
    v_mul_u32_u24 v5, 6554, v4
    v_lshrrev_b32 v5, 16, v5
    v_mul_u32_u24 v6, 10, v5
    v_sub_u32 v0, v4, v6
    v_and_b32 v4, 4, v5
    v_lshlrev_b32 v4, 1, v4
    v_and_b32 v6, 8, v5
    v_lshrrev_b32 v6, 1, v6
    v_and_b32 v5, 0x13, v5
    v_or3_b32 v4, v4, v5, v6
    v_lshrrev_b32 v5, 4, v4
    v_mul_u32_u24 v5, 24, v5
    v_and_b32 v6, 28, v4
    v_mad_u32_u24 v6, v6, 9, 16
    v_cndmask_b32 v5, v5, v6, vcc
    v_add_u32 v4, v4, v5
    v_mul_u32_u24 v4, 1280, v4
    v_lshl_add_u32 v0, v0, 4, v4
    s_lshl_b32 s46, s31, 6
    v_add_u32 v4, s46, v1
    v_mul_u32_u24 v5, 6554, v4
    v_lshrrev_b32 v5, 16, v5
    v_mul_u32_u24 v6, 10, v5
    v_sub_u32 v2, v4, v6
    v_and_b32 v4, 4, v5
    v_lshlrev_b32 v4, 1, v4
    v_and_b32 v6, 8, v5
    v_lshrrev_b32 v6, 1, v6
    v_and_b32 v5, 0x13, v5
    v_or3_b32 v4, v4, v5, v6
    v_lshrrev_b32 v5, 4, v4
    v_mul_u32_u24 v5, 24, v5
    v_and_b32 v6, 28, v4
    v_mad_u32_u24 v6, v6, 9, 16
    v_cndmask_b32 v5, v5, v6, vcc
    v_add_u32 v4, v4, v5
    v_mul_u32_u24 v4, 1280, v4
    v_lshl_add_u32 v2, v2, 4, v4
    s_waitcnt lgkmcnt(0)
    s_barrier
    s_or_b32 s38, s2, s26
    s_cbranch_scc1 L_nononce
    s_or_b32 s21, s21, 0x80000000
    v_mov_b32 v252, s20
    v_mov_b32 v253, s21
    v_mov_b32 v255, 0
    global_store_dwordx2 v255, v[252:253], s[44:45] sc0 sc1
L_nononce:
    s_add_u32 m0, s35, 8192
    s_nop 0
    buffer_load_dwordx4 v80, s[12:15], s33 offen offset:0 lds
    buffer_load_dwordx4 v81, s[12:15], s33 offen offset:1024 lds
    buffer_load_dwordx4 v82, s[12:15], s33 offen offset:2048 lds
    buffer_load_dwordx4 v83, s[12:15], s33 offen offset:3072 lds
    s_waitcnt vmcnt(4)
    s_barrier
    ds_read_b128 v[16:19], v86 offset:0
    ds_read_b64_tr_b16 v[32:33], v88 offset:0
    ds_read_b64_tr_b16 v[34:35], v88 offset:1024
    ds_read_b128 v[20:23], v86 offset:2048
    ds_read_b64_tr_b16 v[36:37], v89 offset:0
    ds_read_b64_tr_b16 v[38:39], v89 offset:1024
    ds_read_b128 v[24:27], v86 offset:4096
    ds_read_b64_tr_b16 v[40:41], v90 offset:0
    ds_read_b64_tr_b16 v[42:43], v90 offset:1024
    ds_read_b128 v[28:31], v86 offset:6144
    ds_read_b64_tr_b16 v[44:45], v91 offset:0
    ds_read_b64_tr_b16 v[46:47], v91 offset:1024
    s_cmp_eq_u32 s29, 0
    s_cbranch_scc0 L_st0B
    s_waitcnt lgkmcnt(0)
    v_mfma_f32_16x16x32_bf16 v[92:95], v[32:35], v[16:19], 0
    ds_read_b128 v[48:51], v87 offset:0
    v_mfma_f32_16x16x32_bf16 v[96:99], v[32:35], v[20:23], 0
    ds_read_b64_tr_b16 v[64:65], v88 offset:8192
    v_mfma_f32_16x16x32_bf16 v[108:111], v[36:39], v[16:19], 0
    ds_read_b64_tr_b16 v[66:67], v88 offset:9216
    v_mfma_f32_16x16x32_bf16 v[112:115], v[36:39], v[20:23], 0
    ds_read_b128 v[52:55], v87 offset:2048
    v_mfma_f32_16x16x32_bf16 v[100:103], v[32:35], v[24:27], 0
    ds_read_b64_tr_b16 v[68:69], v89 offset:8192
    v_mfma_f32_16x16x32_bf16 v[116:119], v[36:39], v[24:27], 0
    ds_read_b64_tr_b16 v[70:71], v89 offset:9216
    v_mfma_f32_16x16x32_bf16 v[124:127], v[40:43], v[16:19], 0
    ds_read_b128 v[56:59], v87 offset:4096
    v_mfma_f32_16x16x32_bf16 v[128:131], v[40:43], v[20:23], 0
    ds_read_b64_tr_b16 v[72:73], v90 offset:8192
    v_mfma_f32_16x16x32_bf16 v[132:135], v[40:43], v[24:27], 0
    ds_read_b64_tr_b16 v[74:75], v90 offset:9216
    v_mfma_f32_16x16x32_bf16 v[104:107], v[32:35], v[28:31], 0
    ds_read_b128 v[60:63], v87 offset:6144
    v_mfma_f32_16x16x32_bf16 v[120:123], v[36:39], v[28:31], 0
    ds_read_b64_tr_b16 v[76:77], v91 offset:8192
    v_mfma_f32_16x16x32_bf16 v[136:139], v[40:43], v[28:31], 0
    ds_read_b64_tr_b16 v[78:79], v91 offset:9216
    v_mfma_f32_16x16x32_bf16 v[140:143], v[44:47], v[16:19], 0
    s_add_u32 m0, s36, 16384
    s_add_u32 s33, s33, 128
    buffer_load_dwordx4 v84, s[16:19], s34 offen offset:0 lds
    v_mfma_f32_16x16x32_bf16 v[144:147], v[44:47], v[20:23], 0
    v_mfma_f32_16x16x32_bf16 v[148:151], v[44:47], v[24:27], 0
    v_mfma_f32_16x16x32_bf16 v[152:155], v[44:47], v[28:31], 0
    buffer_load_dwordx4 v85, s[16:19], s34 offen offset:1024 lds
    s_add_u32 s34, s34, 245760
    s_cmp_eq_u32 s33, 1280
    s_cselect_b32 s33, 0, s33
    s_cselect_b32 s34, 0, s34
    s_waitcnt lgkmcnt(0)
    v_mfma_f32_16x16x32_bf16 v[92:95], v[64:67], v[48:51], v[92:95]
    v_add_u32 v86, 8192, v86
    v_add_u32 v87, 8192, v87
    v_add_u32 v88, 16384, v88
    v_mfma_f32_16x16x32_bf16 v[96:99], v[64:67], v[52:55], v[96:99]
    v_add_u32 v89, 16384, v89
    v_add_u32 v90, 16384, v90
    v_add_u32 v91, 16384, v91
    v_mfma_f32_16x16x32_bf16 v[108:111], v[68:71], v[48:51], v[108:111]
    v_mfma_f32_16x16x32_bf16 v[112:115], v[68:71], v[52:55], v[112:115]
    v_mfma_f32_16x16x32_bf16 v[100:103], v[64:67], v[56:59], v[100:103]
    v_mfma_f32_16x16x32_bf16 v[116:119], v[68:71], v[56:59], v[116:119]
    v_mfma_f32_16x16x32_bf16 v[124:127], v[72:75], v[48:51], v[124:127]
    v_mfma_f32_16x16x32_bf16 v[128:131], v[72:75], v[52:55], v[128:131]
    v_mfma_f32_16x16x32_bf16 v[132:135], v[72:75], v[56:59], v[132:135]
    v_mfma_f32_16x16x32_bf16 v[104:107], v[64:67], v[60:63], v[104:107]
    v_mfma_f32_16x16x32_bf16 v[120:123], v[68:71], v[60:63], v[120:123]
    v_mfma_f32_16x16x32_bf16 v[136:139], v[72:75], v[60:63], v[136:139]
    v_mfma_f32_16x16x32_bf16 v[140:143], v[76:79], v[48:51], v[140:143]
    v_mfma_f32_16x16x32_bf16 v[144:147], v[76:79], v[52:55], v[144:147]
    v_mfma_f32_16x16x32_bf16 v[148:151], v[76:79], v[56:59], v[148:151]
    v_mfma_f32_16x16x32_bf16 v[152:155], v[76:79], v[60:63], v[152:155]
    s_branch L_st0done
L_st0B:
    s_waitcnt lgkmcnt(0)
    v_mfma_f32_16x16x32_bf16 v[92:95], v[32:35], v[16:19], 0
    ds_read_b128 v[48:51], v87 offset:0
    v_mfma_f32_16x16x32_bf16 v[96:99], v[32:35], v[20:23], 0
    ds_read_b64_tr_b16 v[64:65], v88 offset:8192
    v_mfma_f32_16x16x32_bf16 v[108:111], v[16:19], v[36:39], 0
    ds_read_b64_tr_b16 v[66:67], v88 offset:9216
    v_mfma_f32_16x16x32_bf16 v[112:115], v[20:23], v[36:39], 0
    ds_read_b128 v[52:55], v87 offset:2048
    v_mfma_f32_16x16x32_bf16 v[100:103], v[32:35], v[24:27], 0
    ds_read_b64_tr_b16 v[68:69], v89 offset:8192
    v_mfma_f32_16x16x32_bf16 v[116:119], v[24:27], v[36:39], 0
    ds_read_b64_tr_b16 v[70:71], v89 offset:9216
    v_mfma_f32_16x16x32_bf16 v[124:127], v[16:19], v[40:43], 0
    ds_read_b128 v[56:59], v87 offset:4096
    v_mfma_f32_16x16x32_bf16 v[128:131], v[20:23], v[40:43], 0
    ds_read_b64_tr_b16 v[72:73], v90 offset:8192
    v_mfma_f32_16x16x32_bf16 v[132:135], v[24:27], v[40:43], 0
    ds_read_b64_tr_b16 v[74:75], v90 offset:9216
    v_mfma_f32_16x16x32_bf16 v[104:107], v[32:35], v[28:31], 0
    ds_read_b128 v[60:63], v87 offset:6144
    v_mfma_f32_16x16x32_bf16 v[120:123], v[28:31], v[36:39], 0
    ds_read_b64_tr_b16 v[76:77], v91 offset:8192
    v_mfma_f32_16x16x32_bf16 v[136:139], v[28:31], v[40:43], 0
    ds_read_b64_tr_b16 v[78:79], v91 offset:9216
    v_mfma_f32_16x16x32_bf16 v[140:143], v[16:19], v[44:47], 0
    s_add_u32 m0, s36, 16384
    s_add_u32 s33, s33, 128
    buffer_load_dwordx4 v84, s[16:19], s34 offen offset:0 lds
    v_mfma_f32_16x16x32_bf16 v[144:147], v[20:23], v[44:47], 0
    v_mfma_f32_16x16x32_bf16 v[148:151], v[24:27], v[44:47], 0
    v_mfma_f32_16x16x32_bf16 v[152:155], v[28:31], v[44:47], 0
    buffer_load_dwordx4 v85, s[16:19], s34 offen offset:1024 lds
    s_add_u32 s34, s34, 245760
    s_cmp_eq_u32 s33, 1280
    s_cselect_b32 s33, 0, s33
    s_cselect_b32 s34, 0, s34
    s_waitcnt lgkmcnt(0)
    v_mfma_f32_16x16x32_bf16 v[92:95], v[64:67], v[48:51], v[92:95]
    v_add_u32 v86, 8192, v86
    v_add_u32 v87, 8192, v87
    v_add_u32 v88, 16384, v88
    v_mfma_f32_16x16x32_bf16 v[96:99], v[64:67], v[52:55], v[96:99]
    v_add_u32 v89, 16384, v89
    v_add_u32 v90, 16384, v90
    v_add_u32 v91, 16384, v91
    v_mfma_f32_16x16x32_bf16 v[108:111], v[48:51], v[68:71], v[108:111]
    v_mfma_f32_16x16x32_bf16 v[112:115], v[52:55], v[68:71], v[112:115]
    v_mfma_f32_16x16x32_bf16 v[100:103], v[64:67], v[56:59], v[100:103]
    v_mfma_f32_16x16x32_bf16 v[116:119], v[56:59], v[68:71], v[116:119]
    v_mfma_f32_16x16x32_bf16 v[124:127], v[48:51], v[72:75], v[124:127]
    v_mfma_f32_16x16x32_bf16 v[128:131], v[52:55], v[72:75], v[128:131]
    v_mfma_f32_16x16x32_bf16 v[132:135], v[56:59], v[72:75], v[132:135]
    v_mfma_f32_16x16x32_bf16 v[104:107], v[64:67], v[60:63], v[104:107]
    v_mfma_f32_16x16x32_bf16 v[120:123], v[60:63], v[68:71], v[120:123]
    v_mfma_f32_16x16x32_bf16 v[136:139], v[60:63], v[72:75], v[136:139]
    v_mfma_f32_16x16x32_bf16 v[140:143], v[48:51], v[76:79], v[140:143]
    v_mfma_f32_16x16x32_bf16 v[144:147], v[52:55], v[76:79], v[144:147]
    v_mfma_f32_16x16x32_bf16 v[148:151], v[56:59], v[76:79], v[148:151]
    v_mfma_f32_16x16x32_bf16 v[152:155], v[60:63], v[76:79], v[152:155]
L_st0done:
    s_add_u32 m0, s35, 16384
    s_nop 0
    buffer_load_dwordx4 v80, s[12:15], s33 offen offset:0 lds
    buffer_load_dwordx4 v81, s[12:15], s33 offen offset:1024 lds
    buffer_load_dwordx4 v82, s[12:15], s33 offen offset:2048 lds
    buffer_load_dwordx4 v83, s[12:15], s33 offen offset:3072 lds
    s_mov_b32 s40, 1
    s_mov_b32 s37, 1
    s_mov_b32 s41, 0
    s_mov_b32 s42, 0
    s_waitcnt vmcnt(4)
    s_barrier
    ds_read_b128 v[16:19], v86 offset:0
    ds_read_b64_tr_b16 v[32:33], v88 offset:0
    ds_read_b64_tr_b16 v[34:35], v88 offset:1024
    ds_read_b128 v[20:23], v86 offset:2048
    ds_read_b64_tr_b16 v[36:37], v89 offset:0
    ds_read_b64_tr_b16 v[38:39], v89 offset:1024
    ds_read_b128 v[24:27], v86 offset:4096
    ds_read_b64_tr_b16 v[40:41], v90 offset:0
    ds_read_b64_tr_b16 v[42:43], v90 offset:1024
    ds_read_b128 v[28:31], v86 offset:6144
    ds_read_b64_tr_b16 v[44:45], v91 offset:0
    ds_read_b64_tr_b16 v[46:47], v91 offset:1024
    s_cmp_eq_u32 s29, 0
    s_cbranch_scc0 L_gemmB0
L_gemmA0:
    s_waitcnt lgkmcnt(0)
    v_mfma_f32_16x16x32_bf16 v[92:95], v[32:35], v[16:19], v[92:95]
    s_add_u32 m0, s36, 32768
    s_add_u32 s33, s33, 128
    buffer_load_dwordx4 v84, s[16:19], s34 offen offset:0 lds
    ds_read_b128 v[48:51], v87 offset:0
    v_mfma_f32_16x16x32_bf16 v[96:99], v[32:35], v[20:23], v[96:99]
    ds_read_b64_tr_b16 v[64:65], v88 offset:8192
    v_mfma_f32_16x16x32_bf16 v[108:111], v[36:39], v[16:19], v[108:111]
    ds_read_b64_tr_b16 v[66:67], v88 offset:9216
    v_mfma_f32_16x16x32_bf16 v[112:115], v[36:39], v[20:23], v[112:115]
    buffer_load_dwordx4 v85, s[16:19], s34 offen offset:1024 lds
    s_add_u32 s34, s34, 245760
    s_cmp_eq_u32 s33, 1280
    s_cselect_b32 s33, 0, s33
    s_cselect_b32 s34, 0, s34
    ds_read_b128 v[52:55], v87 offset:2048
    v_mfma_f32_16x16x32_bf16 v[100:103], v[32:35], v[24:27], v[100:103]
    ds_read_b64_tr_b16 v[68:69], v89 offset:8192
    v_mfma_f32_16x16x32_bf16 v[116:119], v[36:39], v[24:27], v[116:119]
    ds_read_b64_tr_b16 v[70:71], v89 offset:9216
    v_mfma_f32_16x16x32_bf16 v[124:127], v[40:43], v[16:19], v[124:127]
    s_add_u32 m0, s35, s41
    s_nop 0
    buffer_load_dwordx4 v80, s[12:15], s33 offen offset:0 lds
    ds_read_b128 v[56:59], v87 offset:4096
    v_mfma_f32_16x16x32_bf16 v[128:131], v[40:43], v[20:23], v[128:131]
    ds_read_b64_tr_b16 v[72:73], v90 offset:8192
    v_mfma_f32_16x16x32_bf16 v[132:135], v[40:43], v[24:27], v[132:135]
    ds_read_b64_tr_b16 v[74:75], v90 offset:9216
    v_mfma_f32_16x16x32_bf16 v[104:107], v[32:35], v[28:31], v[104:107]
    buffer_load_dwordx4 v81, s[12:15], s33 offen offset:1024 lds
    ds_read_b128 v[60:63], v87 offset:6144
    v_mfma_f32_16x16x32_bf16 v[120:123], v[36:39], v[28:31], v[120:123]
    ds_read_b64_tr_b16 v[76:77], v91 offset:8192
    v_mfma_f32_16x16x32_bf16 v[136:139], v[40:43], v[28:31], v[136:139]
    ds_read_b64_tr_b16 v[78:79], v91 offset:9216
    v_mfma_f32_16x16x32_bf16 v[140:143], v[44:47], v[16:19], v[140:143]
    buffer_load_dwordx4 v82, s[12:15], s33 offen offset:2048 lds
    buffer_load_dwordx4 v83, s[12:15], s33 offen offset:3072 lds
    v_mfma_f32_16x16x32_bf16 v[144:147], v[44:47], v[20:23], v[144:147]
    s_cmp_eq_u32 s40, 2
    s_cselect_b32 s38, -2, 1
    s_lshl_b32 s39, s38, 14
    s_lshl_b32 s30, s38, 13
    v_mfma_f32_16x16x32_bf16 v[148:151], v[44:47], v[24:27], v[148:151]
    v_add_u32 v86, s30, v86
    v_add_u32 v87, s30, v87
    v_add_u32 v88, s39, v88
    v_mfma_f32_16x16x32_bf16 v[152:155], v[44:47], v[28:31], v[152:155]
    s_add_u32 m0, s36, s42
    s_add_u32 s33, s33, 128
    buffer_load_dwordx4 v84, s[16:19], s34 offen offset:0 lds
    v_add_u32 v89, s39, v89
    v_add_u32 v90, s39, v90
    v_add_u32 v91, s39, v91
    s_waitcnt vmcnt(5) lgkmcnt(0)
    s_barrier
    v_mfma_f32_16x16x32_bf16 v[92:95], v[64:67], v[48:51], v[92:95]
    buffer_load_dwordx4 v85, s[16:19], s34 offen offset:1024 lds
    s_add_u32 s34, s34, 245760
    s_cmp_eq_u32 s33, 1280
    s_cselect_b32 s33, 0, s33
    s_cselect_b32 s34, 0, s34
    ds_read_b128 v[16:19], v86 offset:0
    v_mfma_f32_16x16x32_bf16 v[96:99], v[64:67], v[52:55], v[96:99]
    ds_read_b64_tr_b16 v[32:33], v88 offset:0
    v_mfma_f32_16x16x32_bf16 v[108:111], v[68:71], v[48:51], v[108:111]
    ds_read_b64_tr_b16 v[34:35], v88 offset:1024
    v_mfma_f32_16x16x32_bf16 v[112:115], v[68:71], v[52:55], v[112:115]
    s_lshl_b32 s41, s40, 13
    s_lshl_b32 s42, s40, 14
    s_add_u32 s40, s40, s38
    s_add_u32 m0, s35, s41
    s_nop 0
    buffer_load_dwordx4 v80, s[12:15], s33 offen offset:0 lds
    ds_read_b128 v[20:23], v86 offset:2048
    v_mfma_f32_16x16x32_bf16 v[100:103], v[64:67], v[56:59], v[100:103]
    ds_read_b64_tr_b16 v[36:37], v89 offset:0
    v_mfma_f32_16x16x32_bf16 v[116:119], v[68:71], v[56:59], v[116:119]
    ds_read_b64_tr_b16 v[38:39], v89 offset:1024
    v_mfma_f32_16x16x32_bf16 v[124:127], v[72:75], v[48:51], v[124:127]
    buffer_load_dwordx4 v81, s[12:15], s33 offen offset:1024 lds
    ds_read_b128 v[24:27], v86 offset:4096
    v_mfma_f32_16x16x32_bf16 v[128:131], v[72:75], v[52:55], v[128:131]
    ds_read_b64_tr_b16 v[40:41], v90 offset:0
    v_mfma_f32_16x16x32_bf16 v[132:135], v[72:75], v[56:59], v[132:135]
    ds_read_b64_tr_b16 v[42:43], v90 offset:1024
    v_mfma_f32_16x16x32_bf16 v[104:107], v[64:67], v[60:63], v[104:107]
    buffer_load_dwordx4 v82, s[12:15], s33 offen offset:2048 lds
    ds_read_b128 v[28:31], v86 offset:6144
    v_mfma_f32_16x16x32_bf16 v[120:123], v[68:71], v[60:63], v[120:123]
    ds_read_b64_tr_b16 v[44:45], v91 offset:0
    v_mfma_f32_16x16x32_bf16 v[136:139], v[72:75], v[60:63], v[136:139]
    ds_read_b64_tr_b16 v[46:47], v91 offset:1024
    v_mfma_f32_16x16x32_bf16 v[140:143], v[76:79], v[48:51], v[140:143]
    s_add_u32 s37, s37, 1
    v_mfma_f32_16x16x32_bf16 v[144:147], v[76:79], v[52:55], v[144:147]
    v_mfma_f32_16x16x32_bf16 v[148:151], v[76:79], v[56:59], v[148:151]
    v_mfma_f32_16x16x32_bf16 v[152:155], v[76:79], v[60:63], v[152:155]
L_gemmA:
    s_waitcnt lgkmcnt(0)
    v_mfma_f32_16x16x32_bf16 v[92:95], v[32:35], v[16:19], v[92:95]
    buffer_load_dwordx4 v83, s[12:15], s33 offen offset:3072 lds
    ds_read_b128 v[48:51], v87 offset:0
    v_mfma_f32_16x16x32_bf16 v[96:99], v[32:35], v[20:23], v[96:99]
    ds_read_b64_tr_b16 v[64:65], v88 offset:8192
    v_mfma_f32_16x16x32_bf16 v[108:111], v[36:39], v[16:19], v[108:111]
    ds_read_b64_tr_b16 v[66:67], v88 offset:9216
    v_mfma_f32_16x16x32_bf16 v[112:115], v[36:39], v[20:23], v[112:115]
    s_add_u32 m0, s36, s42
    s_add_u32 s33, s33, 128
    buffer_load_dwordx4 v84, s[16:19], s34 offen offset:0 lds
    ds_read_b128 v[52:55], v87 offset:2048
    v_mfma_f32_16x16x32_bf16 v[100:103], v[32:35], v[24:27], v[100:103]
    ds_read_b64_tr_b16 v[68:69], v89 offset:8192
    v_mfma_f32_16x16x32_bf16 v[116:119], v[36:39], v[24:27], v[116:119]
    ds_read_b64_tr_b16 v[70:71], v89 offset:9216
    v_mfma_f32_16x16x32_bf16 v[124:127], v[40:43], v[16:19], v[124:127]
    ds_read_b128 v[56:59], v87 offset:4096
    v_mfma_f32_16x16x32_bf16 v[128:131], v[40:43], v[20:23], v[128:131]
    ds_read_b64_tr_b16 v[72:73], v90 offset:8192
    v_mfma_f32_16x16x32_bf16 v[132:135], v[40:43], v[24:27], v[132:135]
    ds_read_b64_tr_b16 v[74:75], v90 offset:9216
    v_mfma_f32_16x16x32_bf16 v[104:107], v[32:35], v[28:31], v[104:107]
    ds_read_b128 v[60:63], v87 offset:6144
    v_mfma_f32_16x16x32_bf16 v[120:123], v[36:39], v[28:31], v[120:123]
    ds_read_b64_tr_b16 v[76:77], v91 offset:8192
    v_mfma_f32_16x16x32_bf16 v[136:139], v[40:43], v[28:31], v[136:139]
    ds_read_b64_tr_b16 v[78:79], v91 offset:9216
    v_mfma_f32_16x16x32_bf16 v[140:143], v[44:47], v[16:19], v[140:143]
    s_cmp_eq_u32 s40, 2
    s_cselect_b32 s38, -2, 1
    s_lshl_b32 s39, s38, 14
    s_lshl_b32 s30, s38, 13
    v_mfma_f32_16x16x32_bf16 v[144:147], v[44:47], v[20:23], v[144:147]
    v_add_u32 v86, s30, v86
    v_add_u32 v87, s30, v87
    v_add_u32 v88, s39, v88
    v_mfma_f32_16x16x32_bf16 v[148:151], v[44:47], v[24:27], v[148:151]
    v_add_u32 v89, s39, v89
    v_add_u32 v90, s39, v90
    v_add_u32 v91, s39, v91
    v_mfma_f32_16x16x32_bf16 v[152:155], v[44:47], v[28:31], v[152:155]
    s_waitcnt vmcnt(5) lgkmcnt(0)
    s_barrier
    v_mfma_f32_16x16x32_bf16 v[92:95], v[64:67], v[48:51], v[92:95]
    buffer_load_dwordx4 v85, s[16:19], s34 offen offset:1024 lds
    s_add_u32 s34, s34, 245760
    s_cmp_eq_u32 s33, 1280
    s_cselect_b32 s33, 0, s33
    s_cselect_b32 s34, 0, s34
    ds_read_b128 v[16:19], v86 offset:0
    v_mfma_f32_16x16x32_bf16 v[96:99], v[64:67], v[52:55], v[96:99]
    ds_read_b64_tr_b16 v[32:33], v88 offset:0
    v_mfma_f32_16x16x32_bf16 v[108:111], v[68:71], v[48:51], v[108:111]
    ds_read_b64_tr_b16 v[34:35], v88 offset:1024
    v_mfma_f32_16x16x32_bf16 v[112:115], v[68:71], v[52:55], v[112:115]
    s_lshl_b32 s41, s40, 13
    s_lshl_b32 s42, s40, 14
    s_add_u32 s40, s40, s38
    s_add_u32 m0, s35, s41
    s_nop 0
    buffer_load_dwordx4 v80, s[12:15], s33 offen offset:0 lds
    ds_read_b128 v[20:23], v86 offset:2048
    v_mfma_f32_16x16x32_bf16 v[100:103], v[64:67], v[56:59], v[100:103]
    ds_read_b64_tr_b16 v[36:37], v89 offset:0
    v_mfma_f32_16x16x32_bf16 v[116:119], v[68:71], v[56:59], v[116:119]
    ds_read_b64_tr_b16 v[38:39], v89 offset:1024
    v_mfma_f32_16x16x32_bf16 v[124:127], v[72:75], v[48:51], v[124:127]
    buffer_load_dwordx4 v81, s[12:15], s33 offen offset:1024 lds
    ds_read_b128 v[24:27], v86 offset:4096
    v_mfma_f32_16x16x32_bf16 v[128:131], v[72:75], v[52:55], v[128:131]
    ds_read_b64_tr_b16 v[40:41], v90 offset:0
    v_mfma_f32_16x16x32_bf16 v[132:135], v[72:75], v[56:59], v[132:135]
    ds_read_b64_tr_b16 v[42:43], v90 offset:1024
    v_mfma_f32_16x16x32_bf16 v[104:107], v[64:67], v[60:63], v[104:107]
    buffer_load_dwordx4 v82, s[12:15], s33 offen offset:2048 lds
    ds_read_b128 v[28:31], v86 offset:6144
    v_mfma_f32_16x16x32_bf16 v[120:123], v[68:71], v[60:63], v[120:123]
    ds_read_b64_tr_b16 v[44:45], v91 offset:0
    v_mfma_f32_16x16x32_bf16 v[136:139], v[72:75], v[60:63], v[136:139]
    ds_read_b64_tr_b16 v[46:47], v91 offset:1024
    v_mfma_f32_16x16x32_bf16 v[140:143], v[76:79], v[48:51], v[140:143]
    s_add_u32 s37, s37, 1
    v_mfma_f32_16x16x32_bf16 v[144:147], v[76:79], v[52:55], v[144:147]
    v_mfma_f32_16x16x32_bf16 v[148:151], v[76:79], v[56:59], v[148:151]
    v_mfma_f32_16x16x32_bf16 v[152:155], v[76:79], v[60:63], v[152:155]
    s_cmp_lt_u32 s37, 7
    s_cbranch_scc1 L_gemmA
    s_waitcnt lgkmcnt(0)
    v_mfma_f32_16x16x32_bf16 v[92:95], v[32:35], v[16:19], v[92:95]
    buffer_load_dwordx4 v83, s[12:15], s33 offen offset:3072 lds
    ds_read_b128 v[48:51], v87 offset:0
    v_mfma_f32_16x16x32_bf16 v[96:99], v[32:35], v[20:23], v[96:99]
    ds_read_b64_tr_b16 v[64:65], v88 offset:8192
    v_mfma_f32_16x16x32_bf16 v[108:111], v[36:39], v[16:19], v[108:111]
    ds_read_b64_tr_b16 v[66:67], v88 offset:9216
    v_mfma_f32_16x16x32_bf16 v[112:115], v[36:39], v[20:23], v[112:115]
    s_add_u32 m0, s36, s42
    s_add_u32 s33, s33, 128
    buffer_load_dwordx4 v84, s[16:19], s34 offen offset:0 lds
    ds_read_b128 v[52:55], v87 offset:2048
    v_mfma_f32_16x16x32_bf16 v[100:103], v[32:35], v[24:27], v[100:103]
    ds_read_b64_tr_b16 v[68:69], v89 offset:8192
    v_mfma_f32_16x16x32_bf16 v[116:119], v[36:39], v[24:27], v[116:119]
    ds_read_b64_tr_b16 v[70:71], v89 offset:9216
    v_mfma_f32_16x16x32_bf16 v[124:127], v[40:43], v[16:19], v[124:127]
    ds_read_b128 v[56:59], v87 offset:4096
    v_mfma_f32_16x16x32_bf16 v[128:131], v[40:43], v[20:23], v[128:131]
    ds_read_b64_tr_b16 v[72:73], v90 offset:8192
    v_mfma_f32_16x16x32_bf16 v[132:135], v[40:43], v[24:27], v[132:135]
    ds_read_b64_tr_b16 v[74:75], v90 offset:9216
    v_mfma_f32_16x16x32_bf16 v[104:107], v[32:35], v[28:31], v[104:107]
    ds_read_b128 v[60:63], v87 offset:6144
    v_mfma_f32_16x16x32_bf16 v[120:123], v[36:39], v[28:31], v[120:123]
    ds_read_b64_tr_b16 v[76:77], v91 offset:8192
    v_mfma_f32_16x16x32_bf16 v[136:139], v[40:43], v[28:31], v[136:139]
    ds_read_b64_tr_b16 v[78:79], v91 offset:9216
    v_mfma_f32_16x16x32_bf16 v[140:143], v[44:47], v[16:19], v[140:143]
    s_cmp_eq_u32 s40, 2
    s_cselect_b32 s38, -2, 1
    s_lshl_b32 s39, s38, 14
    s_lshl_b32 s30, s38, 13
    v_mfma_f32_16x16x32_bf16 v[144:147], v[44:47], v[20:23], v[144:147]
    v_add_u32 v86, s30, v86
    v_add_u32 v87, s30, v87
    v_add_u32 v88, s39, v88
    v_mfma_f32_16x16x32_bf16 v[148:151], v[44:47], v[24:27], v[148:151]
    v_add_u32 v89, s39, v89
    v_add_u32 v90, s39, v90
    v_add_u32 v91, s39, v91
    v_mfma_f32_16x16x32_bf16 v[152:155], v[44:47], v[28:31], v[152:155]
    s_waitcnt vmcnt(5) lgkmcnt(0)
    s_barrier
    v_mfma_f32_16x16x32_bf16 v[92:95], v[64:67], v[48:51], v[92:95]
    buffer_load_dwordx4 v85, s[16:19], s34 offen offset:1024 lds
    s_add_u32 s34, s34, 245760
    s_cmp_eq_u32 s33, 1280
    s_cselect_b32 s33, 0, s33
    s_cselect_b32 s34, 0, s34
    ds_read_b128 v[16:19], v86 offset:0
    v_mfma_f32_16x16x32_bf16 v[96:99], v[64:67], v[52:55], v[96:99]
    ds_read_b64_tr_b16 v[32:33], v88 offset:0
    v_mfma_f32_16x16x32_bf16 v[108:111], v[68:71], v[48:51], v[108:111]
    ds_read_b64_tr_b16 v[34:35], v88 offset:1024
    v_mfma_f32_16x16x32_bf16 v[112:115], v[68:71], v[52:55], v[112:115]
    s_lshl_b32 s41, s40, 13
    s_lshl_b32 s42, s40, 14
    s_add_u32 s40, s40, s38
    ds_read_b128 v[20:23], v86 offset:2048
    v_mfma_f32_16x16x32_bf16 v[100:103], v[64:67], v[56:59], v[100:103]
    ds_read_b64_tr_b16 v[36:37], v89 offset:0
    v_mfma_f32_16x16x32_bf16 v[116:119], v[68:71], v[56:59], v[116:119]
    ds_read_b64_tr_b16 v[38:39], v89 offset:1024
    v_mfma_f32_16x16x32_bf16 v[124:127], v[72:75], v[48:51], v[124:127]
    ds_read_b128 v[24:27], v86 offset:4096
    v_mfma_f32_16x16x32_bf16 v[128:131], v[72:75], v[52:55], v[128:131]
    ds_read_b64_tr_b16 v[40:41], v90 offset:0
    v_mfma_f32_16x16x32_bf16 v[132:135], v[72:75], v[56:59], v[132:135]
    ds_read_b64_tr_b16 v[42:43], v90 offset:1024
    v_mfma_f32_16x16x32_bf16 v[104:107], v[64:67], v[60:63], v[104:107]
    ds_read_b128 v[28:31], v86 offset:6144
    v_mfma_f32_16x16x32_bf16 v[120:123], v[68:71], v[60:63], v[120:123]
    ds_read_b64_tr_b16 v[44:45], v91 offset:0
    v_mfma_f32_16x16x32_bf16 v[136:139], v[72:75], v[60:63], v[136:139]
    ds_read_b64_tr_b16 v[46:47], v91 offset:1024
    v_mfma_f32_16x16x32_bf16 v[140:143], v[76:79], v[48:51], v[140:143]
    s_add_u32 s37, s37, 1
    v_mfma_f32_16x16x32_bf16 v[144:147], v[76:79], v[52:55], v[144:147]
    v_mfma_f32_16x16x32_bf16 v[148:151], v[76:79], v[56:59], v[148:151]
    v_mfma_f32_16x16x32_bf16 v[152:155], v[76:79], v[60:63], v[152:155]
    v_mov_b32 v4, 0
    global_load_dwordx2 v[252:253], v4, s[44:45] sc0 sc1
    s_waitcnt lgkmcnt(0)
    v_mfma_f32_16x16x32_bf16 v[92:95], v[32:35], v[16:19], v[92:95]
    ds_read_b128 v[48:51], v87 offset:0
    v_mfma_f32_16x16x32_bf16 v[96:99], v[32:35], v[20:23], v[96:99]
    ds_read_b64_tr_b16 v[64:65], v88 offset:8192
    v_mfma_f32_16x16x32_bf16 v[108:111], v[36:39], v[16:19], v[108:111]
    ds_read_b64_tr_b16 v[66:67], v88 offset:9216
    v_mfma_f32_16x16x32_bf16 v[112:115], v[36:39], v[20:23], v[112:115]
    ds_read_b128 v[52:55], v87 offset:2048
    v_mfma_f32_16x16x32_bf16 v[100:103], v[32:35], v[24:27], v[100:103]
    ds_read_b64_tr_b16 v[68:69], v89 offset:8192
    v_mfma_f32_16x16x32_bf16 v[116:119], v[36:39], v[24:27], v[116:119]
    ds_read_b64_tr_b16 v[70:71], v89 offset:9216
    v_mfma_f32_16x16x32_bf16 v[124:127], v[40:43], v[16:19], v[124:127]
    ds_read_b128 v[56:59], v87 offset:4096
    v_mfma_f32_16x16x32_bf16 v[128:131], v[40:43], v[20:23], v[128:131]
    ds_read_b64_tr_b16 v[72:73], v90 offset:8192
    v_mfma_f32_16x16x32_bf16 v[132:135], v[40:43], v[24:27], v[132:135]
    ds_read_b64_tr_b16 v[74:75], v90 offset:9216
    v_mfma_f32_16x16x32_bf16 v[104:107], v[32:35], v[28:31], v[104:107]
    ds_read_b128 v[60:63], v87 offset:6144
    v_mfma_f32_16x16x32_bf16 v[120:123], v[36:39], v[28:31], v[120:123]
    ds_read_b64_tr_b16 v[76:77], v91 offset:8192
    v_mfma_f32_16x16x32_bf16 v[136:139], v[40:43], v[28:31], v[136:139]
    ds_read_b64_tr_b16 v[78:79], v91 offset:9216
    v_mfma_f32_16x16x32_bf16 v[140:143], v[44:47], v[16:19], v[140:143]
    s_cmp_eq_u32 s40, 2
    s_cselect_b32 s38, -2, 1
    s_lshl_b32 s39, s38, 14
    s_lshl_b32 s30, s38, 13
    v_mfma_f32_16x16x32_bf16 v[144:147], v[44:47], v[20:23], v[144:147]
    v_add_u32 v86, s30, v86
    v_add_u32 v87, s30, v87
    v_add_u32 v88, s39, v88
    v_mfma_f32_16x16x32_bf16 v[148:151], v[44:47], v[24:27], v[148:151]
    v_add_u32 v89, s39, v89
    v_add_u32 v90, s39, v90
    v_add_u32 v91, s39, v91
    v_mfma_f32_16x16x32_bf16 v[152:155], v[44:47], v[28:31], v[152:155]
    s_waitcnt vmcnt(0) lgkmcnt(0)
    s_barrier
    v_mfma_f32_16x16x32_bf16 v[92:95], v[64:67], v[48:51], v[92:95]
    ds_read_b128 v[16:19], v86 offset:0
    v_mfma_f32_16x16x32_bf16 v[96:99], v[64:67], v[52:55], v[96:99]
    ds_read_b64_tr_b16 v[32:33], v88 offset:0
    v_mfma_f32_16x16x32_bf16 v[108:111], v[68:71], v[48:51], v[108:111]
    ds_read_b64_tr_b16 v[34:35], v88 offset:1024
    v_mfma_f32_16x16x32_bf16 v[112:115], v[68:71], v[52:55], v[112:115]
    ds_read_b128 v[20:23], v86 offset:2048
    v_mfma_f32_16x16x32_bf16 v[100:103], v[64:67], v[56:59], v[100:103]
    ds_read_b64_tr_b16 v[36:37], v89 offset:0
    v_mfma_f32_16x16x32_bf16 v[116:119], v[68:71], v[56:59], v[116:119]
    ds_read_b64_tr_b16 v[38:39], v89 offset:1024
    v_mfma_f32_16x16x32_bf16 v[124:127], v[72:75], v[48:51], v[124:127]
    ds_read_b128 v[24:27], v86 offset:4096
    v_mfma_f32_16x16x32_bf16 v[128:131], v[72:75], v[52:55], v[128:131]
    ds_read_b64_tr_b16 v[40:41], v90 offset:0
    v_mfma_f32_16x16x32_bf16 v[132:135], v[72:75], v[56:59], v[132:135]
    ds_read_b64_tr_b16 v[42:43], v90 offset:1024
    v_mfma_f32_16x16x32_bf16 v[104:107], v[64:67], v[60:63], v[104:107]
    ds_read_b128 v[28:31], v86 offset:6144
    v_mfma_f32_16x16x32_bf16 v[120:123], v[68:71], v[60:63], v[120:123]
    ds_read_b64_tr_b16 v[44:45], v91 offset:0
    v_mfma_f32_16x16x32_bf16 v[136:139], v[72:75], v[60:63], v[136:139]
    ds_read_b64_tr_b16 v[46:47], v91 offset:1024
    v_mfma_f32_16x16x32_bf16 v[140:143], v[76:79], v[48:51], v[140:143]
    s_add_u32 s40, s40, s38
    s_and_b32 s31, s2, -8
    s_add_u32 s31, s31, s26
    v_mfma_f32_16x16x32_bf16 v[144:147], v[76:79], v[52:55], v[144:147]
    s_mul_i32 s31, s31, 3200
    v_min_u32 v255, 24, v1
    v_lshl_add_u32 v255, v255, 7, s31
    v_mfma_f32_16x16x32_bf16 v[148:151], v[76:79], v[56:59], v[148:151]
    s_lshl_b32 s31, s23, 1
    s_add_u32 s31, s31, s29
    s_lshl_b32 s31, s31, 3
    v_mfma_f32_16x16x32_bf16 v[152:155], v[76:79], v[60:63], v[152:155]
    s_add_u32 s43, s31, s52
    s_and_b32 s32, s24, 7
    s_mul_i32 s32, s32, 160
    s_sub_u32 s18, 819200, s32
    s_add_u32 s16, s56, s32
    s_addc_u32 s17, s57, 0
    s_mov_b32 s14, 5242880
    s_mov_b64 s[12:13], s[58:59]
    s_waitcnt lgkmcnt(0)
    v_mfma_f32_16x16x32_bf16 v[92:95], v[32:35], v[16:19], v[92:95]
    ds_read_b128 v[48:51], v87 offset:0
    v_mfma_f32_16x16x32_bf16 v[96:99], v[32:35], v[20:23], v[96:99]
    ds_read_b64_tr_b16 v[64:65], v88 offset:8192
    v_mfma_f32_16x16x32_bf16 v[108:111], v[36:39], v[16:19], v[108:111]
    ds_read_b64_tr_b16 v[66:67], v88 offset:9216
    v_mfma_f32_16x16x32_bf16 v[112:115], v[36:39], v[20:23], v[112:115]
    ds_read_b128 v[52:55], v87 offset:2048
    v_mfma_f32_16x16x32_bf16 v[100:103], v[32:35], v[24:27], v[100:103]
    ds_read_b64_tr_b16 v[68:69], v89 offset:8192
    v_mfma_f32_16x16x32_bf16 v[116:119], v[36:39], v[24:27], v[116:119]
    ds_read_b64_tr_b16 v[70:71], v89 offset:9216
    v_mfma_f32_16x16x32_bf16 v[124:127], v[40:43], v[16:19], v[124:127]
    ds_read_b128 v[56:59], v87 offset:4096
    v_mfma_f32_16x16x32_bf16 v[128:131], v[40:43], v[20:23], v[128:131]
    ds_read_b64_tr_b16 v[72:73], v90 offset:8192
    v_mfma_f32_16x16x32_bf16 v[132:135], v[40:43], v[24:27], v[132:135]
    ds_read_b64_tr_b16 v[74:75], v90 offset:9216
    v_mfma_f32_16x16x32_bf16 v[104:107], v[32:35], v[28:31], v[104:107]
    ds_read_b128 v[60:63], v87 offset:6144
    v_mfma_f32_16x16x32_bf16 v[120:123], v[36:39], v[28:31], v[120:123]
    ds_read_b64_tr_b16 v[76:77], v91 offset:8192
    v_mfma_f32_16x16x32_bf16 v[136:139], v[40:43], v[28:31], v[136:139]
    ds_read_b64_tr_b16 v[78:79], v91 offset:9216
    v_mfma_f32_16x16x32_bf16 v[140:143], v[44:47], v[16:19], v[140:143]
    v_readfirstlane_b32 s21, v253
    v_readfirstlane_b32 s20, v252
    s_add_u32 s31, s51, 3072
    v_mfma_f32_16x16x32_bf16 v[144:147], v[44:47], v[20:23], v[144:147]
    s_mov_b32 s46, 0x3ea52b5c
    s_mov_b32 s47, s46
    s_cmp_eq_u32 s21, 0
    s_cbranch_scc1 L_nonce0
L_nonce_ok0:
    v_mfma_f32_16x16x32_bf16 v[148:151], v[44:47], v[24:27], v[148:151]
    v_mfma_f32_16x16x32_bf16 v[152:155], v[44:47], v[28:31], v[152:155]
    s_waitcnt lgkmcnt(0)
    s_barrier
    v_mfma_f32_16x16x32_bf16 v[124:127], v[72:75], v[48:51], v[124:127]
    v_mfma_f32_16x16x32_bf16 v[140:143], v[76:79], v[48:51], v[140:143]
    ds_write_b128 v3, v[156:159] offset:0
    v_mfma_f32_16x16x32_bf16 v[128:131], v[72:75], v[52:55], v[128:131]
    v_mfma_f32_16x16x32_bf16 v[144:147], v[76:79], v[52:55], v[144:147]
    v_mfma_f32_16x16x32_bf16 v[132:135], v[72:75], v[56:59], v[132:135]
    v_mfma_f32_16x16x32_bf16 v[148:151], v[76:79], v[56:59], v[148:151]
    v_mfma_f32_16x16x32_bf16 v[136:139], v[72:75], v[60:63], v[136:139]
    v_mfma_f32_16x16x32_bf16 v[152:155], v[76:79], v[60:63], v[152:155]
    s_nop 0
    v_cvt_pk_bf16_f32 v16, v124, v125
    v_cvt_pk_bf16_f32 v17, v126, v127
    v_cvt_pk_bf16_f32 v18, v140, v141
    v_cvt_pk_bf16_f32 v19, v142, v143
    ds_write_b128 v245, v[16:19] offset:0
    buffer_store_dwordx4 v[16:19], v13, s[8:11], s51 offen offset:0 sc1
    v_mfma_f32_16x16x32_bf16 v[92:95], v[64:67], v[48:51], v[92:95]
    v_mfma_f32_16x16x32_bf16 v[108:111], v[68:71], v[48:51], v[108:111]
    v_cvt_pk_bf16_f32 v20, v128, v129
    v_cvt_pk_bf16_f32 v21, v130, v131
    v_cvt_pk_bf16_f32 v22, v144, v145
    v_cvt_pk_bf16_f32 v23, v146, v147
    ds_write_b128 v245, v[20:23] offset:1024
    buffer_store_dwordx4 v[20:23], v13, s[8:11], s51 offen offset:1024 sc1
    v_mfma_f32_16x16x32_bf16 v[96:99], v[64:67], v[52:55], v[96:99]
    v_mfma_f32_16x16x32_bf16 v[112:115], v[68:71], v[52:55], v[112:115]
    v_cvt_pk_bf16_f32 v24, v132, v133
    v_cvt_pk_bf16_f32 v25, v134, v135
    v_cvt_pk_bf16_f32 v26, v148, v149
    v_cvt_pk_bf16_f32 v27, v150, v151
    ds_write_b128 v245, v[24:27] offset:2048
    buffer_store_dwordx4 v[24:27], v13, s[8:11], s51 offen offset:2048 sc1
    v_mfma_f32_16x16x32_bf16 v[100:103], v[64:67], v[56:59], v[100:103]
    v_mfma_f32_16x16x32_bf16 v[116:119], v[68:71], v[56:59], v[116:119]
    v_cvt_pk_bf16_f32 v28, v136, v137
    v_cvt_pk_bf16_f32 v29, v138, v139
    v_cvt_pk_bf16_f32 v30, v152, v153
    v_cvt_pk_bf16_f32 v31, v154, v155
    ds_write_b128 v245, v[28:31] offset:3072
    buffer_store_dwordx4 v[28:31], v13, s[8:11], s51 offen offset:3072 sc1
    v_mfma_f32_16x16x32_bf16 v[104:107], v[64:67], v[60:63], v[104:107]
    v_mfma_f32_16x16x32_bf16 v[120:123], v[68:71], v[60:63], v[120:123]
    v_pk_mul_f32 v[92:93], v[92:93], s[46:47]
    v_pk_mul_f32 v[94:95], v[94:95], s[46:47]
    v_pk_mul_f32 v[108:109], v[108:109], s[46:47]
    v_pk_mul_f32 v[110:111], v[110:111], s[46:47]
    v_cvt_pk_bf16_f32 v32, v92, v93
    v_cvt_pk_bf16_f32 v33, v94, v95
    v_cvt_pk_bf16_f32 v34, v108, v109
    v_cvt_pk_bf16_f32 v35, v110, v111
    ds_write_b128 v245, v[32:35] offset:12288
    v_pk_mul_f32 v[96:97], v[96:97], s[46:47]
    v_pk_mul_f32 v[98:99], v[98:99], s[46:47]
    v_pk_mul_f32 v[112:113], v[112:113], s[46:47]
    v_pk_mul_f32 v[114:115], v[114:115], s[46:47]
    v_cvt_pk_bf16_f32 v36, v96, v97
    v_cvt_pk_bf16_f32 v37, v98, v99
    v_cvt_pk_bf16_f32 v38, v112, v113
    v_cvt_pk_bf16_f32 v39, v114, v115
    ds_write_b128 v245, v[36:39] offset:13312
    v_pk_mul_f32 v[100:101], v[100:101], s[46:47]
    v_pk_mul_f32 v[102:103], v[102:103], s[46:47]
    v_pk_mul_f32 v[116:117], v[116:117], s[46:47]
    v_pk_mul_f32 v[118:119], v[118:119], s[46:47]
    v_cvt_pk_bf16_f32 v40, v100, v101
    v_cvt_pk_bf16_f32 v41, v102, v103
    v_cvt_pk_bf16_f32 v42, v116, v117
    v_cvt_pk_bf16_f32 v43, v118, v119
    ds_write_b128 v245, v[40:43] offset:14336
    v_pk_mul_f32 v[104:105], v[104:105], s[46:47]
    v_pk_mul_f32 v[106:107], v[106:107], s[46:47]
    v_pk_mul_f32 v[120:121], v[120:121], s[46:47]
    v_pk_mul_f32 v[122:123], v[122:123], s[46:47]
    v_cvt_pk_bf16_f32 v44, v104, v105
    v_cvt_pk_bf16_f32 v45, v106, v107
    v_cvt_pk_bf16_f32 v46, v120, v121
    v_cvt_pk_bf16_f32 v47, v122, v123
    ds_write_b128 v245, v[44:47] offset:15360
    s_setprio 2
    s_waitcnt lgkmcnt(0)
    s_barrier
    s_branch L_epi_done
L_gemmB0:
    s_waitcnt lgkmcnt(0)
    v_mfma_f32_16x16x32_bf16 v[92:95], v[32:35], v[16:19], v[92:95]
    s_add_u32 m0, s36, 32768
    s_add_u32 s33, s33, 128
    buffer_load_dwordx4 v84, s[16:19], s34 offen offset:0 lds
    ds_read_b128 v[48:51], v87 offset:0
    v_mfma_f32_16x16x32_bf16 v[96:99], v[32:35], v[20:23], v[96:99]
    ds_read_b64_tr_b16 v[64:65], v88 offset:8192
    v_mfma_f32_16x16x32_bf16 v[108:111], v[16:19], v[36:39], v[108:111]
    ds_read_b64_tr_b16 v[66:67], v88 offset:9216
    v_mfma_f32_16x16x32_bf16 v[112:115], v[20:23], v[36:39], v[112:115]
    buffer_load_dwordx4 v85, s[16:19], s34 offen offset:1024 lds
    s_add_u32 s34, s34, 245760
    s_cmp_eq_u32 s33, 1280
    s_cselect_b32 s33, 0, s33
    s_cselect_b32 s34, 0, s34
    ds_read_b128 v[52:55], v87 offset:2048
    v_mfma_f32_16x16x32_bf16 v[100:103], v[32:35], v[24:27], v[100:103]
    ds_read_b64_tr_b16 v[68:69], v89 offset:8192
    v_mfma_f32_16x16x32_bf16 v[116:119], v[24:27], v[36:39], v[116:119]
    ds_read_b64_tr_b16 v[70:71], v89 offset:9216
    v_mfma_f32_16x16x32_bf16 v[124:127], v[16:19], v[40:43], v[124:127]
    s_add_u32 m0, s35, s41
    s_nop 0
    buffer_load_dwordx4 v80, s[12:15], s33 offen offset:0 lds
    ds_read_b128 v[56:59], v87 offset:4096
    v_mfma_f32_16x16x32_bf16 v[128:131], v[20:23], v[40:43], v[128:131]
    ds_read_b64_tr_b16 v[72:73], v90 offset:8192
    v_mfma_f32_16x16x32_bf16 v[132:135], v[24:27], v[40:43], v[132:135]
    ds_read_b64_tr_b16 v[74:75], v90 offset:9216
    v_mfma_f32_16x16x32_bf16 v[104:107], v[32:35], v[28:31], v[104:107]
    buffer_load_dwordx4 v81, s[12:15], s33 offen offset:1024 lds
    ds_read_b128 v[60:63], v87 offset:6144
    v_mfma_f32_16x16x32_bf16 v[120:123], v[28:31], v[36:39], v[120:123]
    ds_read_b64_tr_b16 v[76:77], v91 offset:8192
    v_mfma_f32_16x16x32_bf16 v[136:139], v[28:31], v[40:43], v[136:139]
    ds_read_b64_tr_b16 v[78:79], v91 offset:9216
    v_mfma_f32_16x16x32_bf16 v[140:143], v[16:19], v[44:47], v[140:143]
    buffer_load_dwordx4 v82, s[12:15], s33 offen offset:2048 lds
    buffer_load_dwordx4 v83, s[12:15], s33 offen offset:3072 lds
    v_mfma_f32_16x16x32_bf16 v[144:147], v[20:23], v[44:47], v[144:147]
    s_cmp_eq_u32 s40, 2
    s_cselect_b32 s38, -2, 1
    s_lshl_b32 s39, s38, 14
    s_lshl_b32 s30, s38, 13
    v_mfma_f32_16x16x32_bf16 v[148:151], v[24:27], v[44:47], v[148:151]
    v_add_u32 v86, s30, v86
    v_add_u32 v87, s30, v87
    v_add_u32 v88, s39, v88
    v_mfma_f32_16x16x32_bf16 v[152:155], v[28:31], v[44:47], v[152:155]
    s_add_u32 m0, s36, s42
    s_add_u32 s33, s33, 128
    buffer_load_dwordx4 v84, s[16:19], s34 offen offset:0 lds
    v_add_u32 v89, s39, v89
    v_add_u32 v90, s39, v90
    v_add_u32 v91, s39, v91
    s_waitcnt vmcnt(5) lgkmcnt(0)
    s_barrier
    v_mfma_f32_16x16x32_bf16 v[92:95], v[64:67], v[48:51], v[92:95]
    buffer_load_dwordx4 v85, s[16:19], s34 offen offset:1024 lds
    s_add_u32 s34, s34, 245760
    s_cmp_eq_u32 s33, 1280
    s_cselect_b32 s33, 0, s33
    s_cselect_b32 s34, 0, s34
    ds_read_b128 v[16:19], v86 offset:0
    v_mfma_f32_16x16x32_bf16 v[96:99], v[64:67], v[52:55], v[96:99]
    ds_read_b64_tr_b16 v[32:33], v88 offset:0
    v_mfma_f32_16x16x32_bf16 v[108:111], v[48:51], v[68:71], v[108:111]
    ds_read_b64_tr_b16 v[34:35], v88 offset:1024
    v_mfma_f32_16x16x32_bf16 v[112:115], v[52:55], v[68:71], v[112:115]
    s_lshl_b32 s41, s40, 13
    s_lshl_b32 s42, s40, 14
    s_add_u32 s40, s40, s38
    s_add_u32 m0, s35, s41
    s_nop 0
    buffer_load_dwordx4 v80, s[12:15], s33 offen offset:0 lds
    ds_read_b128 v[20:23], v86 offset:2048
    v_mfma_f32_16x16x32_bf16 v[100:103], v[64:67], v[56:59], v[100:103]
    ds_read_b64_tr_b16 v[36:37], v89 offset:0
    v_mfma_f32_16x16x32_bf16 v[116:119], v[56:59], v[68:71], v[116:119]
    ds_read_b64_tr_b16 v[38:39], v89 offset:1024
    v_mfma_f32_16x16x32_bf16 v[124:127], v[48:51], v[72:75], v[124:127]
    buffer_load_dwordx4 v81, s[12:15], s33 offen offset:1024 lds
    ds_read_b128 v[24:27], v86 offset:4096
    v_mfma_f32_16x16x32_bf16 v[128:131], v[52:55], v[72:75], v[128:131]
    ds_read_b64_tr_b16 v[40:41], v90 offset:0
    v_mfma_f32_16x16x32_bf16 v[132:135], v[56:59], v[72:75], v[132:135]
    ds_read_b64_tr_b16 v[42:43], v90 offset:1024
    v_mfma_f32_16x16x32_bf16 v[104:107], v[64:67], v[60:63], v[104:107]
    buffer_load_dwordx4 v82, s[12:15], s33 offen offset:2048 lds
    ds_read_b128 v[28:31], v86 offset:6144
    v_mfma_f32_16x16x32_bf16 v[120:123], v[60:63], v[68:71], v[120:123]
    ds_read_b64_tr_b16 v[44:45], v91 offset:0
    v_mfma_f32_16x16x32_bf16 v[136:139], v[60:63], v[72:75], v[136:139]
    ds_read_b64_tr_b16 v[46:47], v91 offset:1024
    v_mfma_f32_16x16x32_bf16 v[140:143], v[48:51], v[76:79], v[140:143]
    s_add_u32 s37, s37, 1
    v_mfma_f32_16x16x32_bf16 v[144:147], v[52:55], v[76:79], v[144:147]
    v_mfma_f32_16x16x32_bf16 v[148:151], v[56:59], v[76:79], v[148:151]
    v_mfma_f32_16x16x32_bf16 v[152:155], v[60:63], v[76:79], v[152:155]
L_gemmB:
    s_waitcnt lgkmcnt(0)
    v_mfma_f32_16x16x32_bf16 v[92:95], v[32:35], v[16:19], v[92:95]
    buffer_load_dwordx4 v83, s[12:15], s33 offen offset:3072 lds
    ds_read_b128 v[48:51], v87 offset:0
    v_mfma_f32_16x16x32_bf16 v[96:99], v[32:35], v[20:23], v[96:99]
    ds_read_b64_tr_b16 v[64:65], v88 offset:8192
    v_mfma_f32_16x16x32_bf16 v[108:111], v[16:19], v[36:39], v[108:111]
    ds_read_b64_tr_b16 v[66:67], v88 offset:9216
    v_mfma_f32_16x16x32_bf16 v[112:115], v[20:23], v[36:39], v[112:115]
    s_add_u32 m0, s36, s42
    s_add_u32 s33, s33, 128
    buffer_load_dwordx4 v84, s[16:19], s34 offen offset:0 lds
    ds_read_b128 v[52:55], v87 offset:2048
    v_mfma_f32_16x16x32_bf16 v[100:103], v[32:35], v[24:27], v[100:103]
    ds_read_b64_tr_b16 v[68:69], v89 offset:8192
    v_mfma_f32_16x16x32_bf16 v[116:119], v[24:27], v[36:39], v[116:119]
    ds_read_b64_tr_b16 v[70:71], v89 offset:9216
    v_mfma_f32_16x16x32_bf16 v[124:127], v[16:19], v[40:43], v[124:127]
    ds_read_b128 v[56:59], v87 offset:4096
    v_mfma_f32_16x16x32_bf16 v[128:131], v[20:23], v[40:43], v[128:131]
    ds_read_b64_tr_b16 v[72:73], v90 offset:8192
    v_mfma_f32_16x16x32_bf16 v[132:135], v[24:27], v[40:43], v[132:135]
    ds_read_b64_tr_b16 v[74:75], v90 offset:9216
    v_mfma_f32_16x16x32_bf16 v[104:107], v[32:35], v[28:31], v[104:107]
    ds_read_b128 v[60:63], v87 offset:6144
    v_mfma_f32_16x16x32_bf16 v[120:123], v[28:31], v[36:39], v[120:123]
    ds_read_b64_tr_b16 v[76:77], v91 offset:8192
    v_mfma_f32_16x16x32_bf16 v[136:139], v[28:31], v[40:43], v[136:139]
    ds_read_b64_tr_b16 v[78:79], v91 offset:9216
    v_mfma_f32_16x16x32_bf16 v[140:143], v[16:19], v[44:47], v[140:143]
    s_cmp_eq_u32 s40, 2
    s_cselect_b32 s38, -2, 1
    s_lshl_b32 s39, s38, 14
    s_lshl_b32 s30, s38, 13
    v_mfma_f32_16x16x32_bf16 v[144:147], v[20:23], v[44:47], v[144:147]
    v_add_u32 v86, s30, v86
    v_add_u32 v87, s30, v87
    v_add_u32 v88, s39, v88
    v_mfma_f32_16x16x32_bf16 v[148:151], v[24:27], v[44:47], v[148:151]
    v_add_u32 v89, s39, v89
    v_add_u32 v90, s39, v90
    v_add_u32 v91, s39, v91
    v_mfma_f32_16x16x32_bf16 v[152:155], v[28:31], v[44:47], v[152:155]
    s_waitcnt vmcnt(5) lgkmcnt(0)
    s_barrier
    v_mfma_f32_16x16x32_bf16 v[92:95], v[64:67], v[48:51], v[92:95]
    buffer_load_dwordx4 v85, s[16:19], s34 offen offset:1024 lds
    s_add_u32 s34, s34, 245760
    s_cmp_eq_u32 s33, 1280
    s_cselect_b32 s33, 0, s33
    s_cselect_b32 s34, 0, s34
    ds_read_b128 v[16:19], v86 offset:0
    v_mfma_f32_16x16x32_bf16 v[96:99], v[64:67], v[52:55], v[96:99]
    ds_read_b64_tr_b16 v[32:33], v88 offset:0
    v_mfma_f32_16x16x32_bf16 v[108:111], v[48:51], v[68:71], v[108:111]
    ds_read_b64_tr_b16 v[34:35], v88 offset:1024
    v_mfma_f32_16x16x32_bf16 v[112:115], v[52:55], v[68:71], v[112:115]
    s_lshl_b32 s41, s40, 13
    s_lshl_b32 s42, s40, 14
    s_add_u32 s40, s40, s38
    s_add_u32 m0, s35, s41
    s_nop 0
    buffer_load_dwordx4 v80, s[12:15], s33 offen offset:0 lds
    ds_read_b128 v[20:23], v86 offset:2048
    v_mfma_f32_16x16x32_bf16 v[100:103], v[64:67], v[56:59], v[100:103]
    ds_read_b64_tr_b16 v[36:37], v89 offset:0
    v_mfma_f32_16x16x32_bf16 v[116:119], v[56:59], v[68:71], v[116:119]
    ds_read_b64_tr_b16 v[38:39], v89 offset:1024
    v_mfma_f32_16x16x32_bf16 v[124:127], v[48:51], v[72:75], v[124:127]
    buffer_load_dwordx4 v81, s[12:15], s33 offen offset:1024 lds
    ds_read_b128 v[24:27], v86 offset:4096
    v_mfma_f32_16x16x32_bf16 v[128:131], v[52:55], v[72:75], v[128:131]
    ds_read_b64_tr_b16 v[40:41], v90 offset:0
    v_mfma_f32_16x16x32_bf16 v[132:135], v[56:59], v[72:75], v[132:135]
    ds_read_b64_tr_b16 v[42:43], v90 offset:1024
    v_mfma_f32_16x16x32_bf16 v[104:107], v[64:67], v[60:63], v[104:107]
    buffer_load_dwordx4 v82, s[12:15], s33 offen offset:2048 lds
    ds_read_b128 v[28:31], v86 offset:6144
    v_mfma_f32_16x16x32_bf16 v[120:123], v[60:63], v[68:71], v[120:123]
    ds_read_b64_tr_b16 v[44:45], v91 offset:0
    v_mfma_f32_16x16x32_bf16 v[136:139], v[60:63], v[72:75], v[136:139]
    ds_read_b64_tr_b16 v[46:47], v91 offset:1024
    v_mfma_f32_16x16x32_bf16 v[140:143], v[48:51], v[76:79], v[140:143]
    s_add_u32 s37, s37, 1
    v_mfma_f32_16x16x32_bf16 v[144:147], v[52:55], v[76:79], v[144:147]
    v_mfma_f32_16x16x32_bf16 v[148:151], v[56:59], v[76:79], v[148:151]
    v_mfma_f32_16x16x32_bf16 v[152:155], v[60:63], v[76:79], v[152:155]
    s_cmp_lt_u32 s37, 7
    s_cbranch_scc1 L_gemmB
    s_waitcnt lgkmcnt(0)
    v_mfma_f32_16x16x32_bf16 v[92:95], v[32:35], v[16:19], v[92:95]
    buffer_load_dwordx4 v83, s[12:15], s33 offen offset:3072 lds
    ds_read_b128 v[48:51], v87 offset:0
    v_mfma_f32_16x16x32_bf16 v[96:99], v[32:35], v[20:23], v[96:99]
    ds_read_b64_tr_b16 v[64:65], v88 offset:8192
    v_mfma_f32_16x16x32_bf16 v[108:111], v[16:19], v[36:39], v[108:111]
    ds_read_b64_tr_b16 v[66:67], v88 offset:9216
    v_mfma_f32_16x16x32_bf16 v[112:115], v[20:23], v[36:39], v[112:115]
    s_add_u32 m0, s36, s42
    s_add_u32 s33, s33, 128
    buffer_load_dwordx4 v84, s[16:19], s34 offen offset:0 lds
    ds_read_b128 v[52:55], v87 offset:2048
    v_mfma_f32_16x16x32_bf16 v[100:103], v[32:35], v[24:27], v[100:103]
    ds_read_b64_tr_b16 v[68:69], v89 offset:8192
    v_mfma_f32_16x16x32_bf16 v[116:119], v[24:27], v[36:39], v[116:119]
    ds_read_b64_tr_b16 v[70:71], v89 offset:9216
    v_mfma_f32_16x16x32_bf16 v[124:127], v[16:19], v[40:43], v[124:127]
    ds_read_b128 v[56:59], v87 offset:4096
    v_mfma_f32_16x16x32_bf16 v[128:131], v[20:23], v[40:43], v[128:131]
    ds_read_b64_tr_b16 v[72:73], v90 offset:8192
    v_mfma_f32_16x16x32_bf16 v[132:135], v[24:27], v[40:43], v[132:135]
    ds_read_b64_tr_b16 v[74:75], v90 offset:9216
    v_mfma_f32_16x16x32_bf16 v[104:107], v[32:35], v[28:31], v[104:107]
    ds_read_b128 v[60:63], v87 offset:6144
    v_mfma_f32_16x16x32_bf16 v[120:123], v[28:31], v[36:39], v[120:123]
    ds_read_b64_tr_b16 v[76:77], v91 offset:8192
    v_mfma_f32_16x16x32_bf16 v[136:139], v[28:31], v[40:43], v[136:139]
    ds_read_b64_tr_b16 v[78:79], v91 offset:9216
    v_mfma_f32_16x16x32_bf16 v[140:143], v[16:19], v[44:47], v[140:143]
    s_cmp_eq_u32 s40, 2
    s_cselect_b32 s38, -2, 1
    s_lshl_b32 s39, s38, 14
    s_lshl_b32 s30, s38, 13
    v_mfma_f32_16x16x32_bf16 v[144:147], v[20:23], v[44:47], v[144:147]
    v_add_u32 v86, s30, v86
    v_add_u32 v87, s30, v87
    v_add_u32 v88, s39, v88
    v_mfma_f32_16x16x32_bf16 v[148:151], v[24:27], v[44:47], v[148:151]
    v_add_u32 v89, s39, v89
    v_add_u32 v90, s39, v90
    v_add_u32 v91, s39, v91
    v_mfma_f32_16x16x32_bf16 v[152:155], v[28:31], v[44:47], v[152:155]
    s_waitcnt vmcnt(5) lgkmcnt(0)
    s_barrier
    v_mfma_f32_16x16x32_bf16 v[92:95], v[64:67], v[48:51], v[92:95]
    buffer_load_dwordx4 v85, s[16:19], s34 offen offset:1024 lds
    s_add_u32 s34, s34, 245760
    s_cmp_eq_u32 s33, 1280
    s_cselect_b32 s33, 0, s33
    s_cselect_b32 s34, 0, s34
    ds_read_b128 v[16:19], v86 offset:0
    v_mfma_f32_16x16x32_bf16 v[96:99], v[64:67], v[52:55], v[96:99]
    ds_read_b64_tr_b16 v[32:33], v88 offset:0
    v_mfma_f32_16x16x32_bf16 v[108:111], v[48:51], v[68:71], v[108:111]
    ds_read_b64_tr_b16 v[34:35], v88 offset:1024
    v_mfma_f32_16x16x32_bf16 v[112:115], v[52:55], v[68:71], v[112:115]
    s_lshl_b32 s41, s40, 13
    s_lshl_b32 s42, s40, 14
    s_add_u32 s40, s40, s38
    ds_read_b128 v[20:23], v86 offset:2048
    v_mfma_f32_16x16x32_bf16 v[100:103], v[64:67], v[56:59], v[100:103]
    ds_read_b64_tr_b16 v[36:37], v89 offset:0
    v_mfma_f32_16x16x32_bf16 v[116:119], v[56:59], v[68:71], v[116:119]
    ds_read_b64_tr_b16 v[38:39], v89 offset:1024
    v_mfma_f32_16x16x32_bf16 v[124:127], v[48:51], v[72:75], v[124:127]
    ds_read_b128 v[24:27], v86 offset:4096
    v_mfma_f32_16x16x32_bf16 v[128:131], v[52:55], v[72:75], v[128:131]
    ds_read_b64_tr_b16 v[40:41], v90 offset:0
    v_mfma_f32_16x16x32_bf16 v[132:135], v[56:59], v[72:75], v[132:135]
    ds_read_b64_tr_b16 v[42:43], v90 offset:1024
    v_mfma_f32_16x16x32_bf16 v[104:107], v[64:67], v[60:63], v[104:107]
    ds_read_b128 v[28:31], v86 offset:6144
    v_mfma_f32_16x16x32_bf16 v[120:123], v[60:63], v[68:71], v[120:123]
    ds_read_b64_tr_b16 v[44:45], v91 offset:0
    v_mfma_f32_16x16x32_bf16 v[136:139], v[60:63], v[72:75], v[136:139]
    ds_read_b64_tr_b16 v[46:47], v91 offset:1024
    v_mfma_f32_16x16x32_bf16 v[140:143], v[48:51], v[76:79], v[140:143]
    s_add_u32 s37, s37, 1
    v_mfma_f32_16x16x32_bf16 v[144:147], v[52:55], v[76:79], v[144:147]
    v_mfma_f32_16x16x32_bf16 v[148:151], v[56:59], v[76:79], v[148:151]
    v_mfma_f32_16x16x32_bf16 v[152:155], v[60:63], v[76:79], v[152:155]
    v_mov_b32 v4, 0
    global_load_dwordx2 v[252:253], v4, s[44:45] sc0 sc1
    s_waitcnt lgkmcnt(0)
    v_mfma_f32_16x16x32_bf16 v[92:95], v[32:35], v[16:19], v[92:95]
    ds_read_b128 v[48:51], v87 offset:0
    v_mfma_f32_16x16x32_bf16 v[96:99], v[32:35], v[20:23], v[96:99]
    ds_read_b64_tr_b16 v[64:65], v88 offset:8192
    v_mfma_f32_16x16x32_bf16 v[108:111], v[16:19], v[36:39], v[108:111]
    ds_read_b64_tr_b16 v[66:67], v88 offset:9216
    v_mfma_f32_16x16x32_bf16 v[112:115], v[20:23], v[36:39], v[112:115]
    ds_read_b128 v[52:55], v87 offset:2048
    v_mfma_f32_16x16x32_bf16 v[100:103], v[32:35], v[24:27], v[100:103]
    ds_read_b64_tr_b16 v[68:69], v89 offset:8192
    v_mfma_f32_16x16x32_bf16 v[116:119], v[24:27], v[36:39], v[116:119]
    ds_read_b64_tr_b16 v[70:71], v89 offset:9216
    v_mfma_f32_16x16x32_bf16 v[124:127], v[16:19], v[40:43], v[124:127]
    ds_read_b128 v[56:59], v87 offset:4096
    v_mfma_f32_16x16x32_bf16 v[128:131], v[20:23], v[40:43], v[128:131]
    ds_read_b64_tr_b16 v[72:73], v90 offset:8192
    v_mfma_f32_16x16x32_bf16 v[132:135], v[24:27], v[40:43], v[132:135]
    ds_read_b64_tr_b16 v[74:75], v90 offset:9216
    v_mfma_f32_16x16x32_bf16 v[104:107], v[32:35], v[28:31], v[104:107]
    ds_read_b128 v[60:63], v87 offset:6144
    v_mfma_f32_16x16x32_bf16 v[120:123], v[28:31], v[36:39], v[120:123]
    ds_read_b64_tr_b16 v[76:77], v91 offset:8192
    v_mfma_f32_16x16x32_bf16 v[136:139], v[28:31], v[40:43], v[136:139]
    ds_read_b64_tr_b16 v[78:79], v91 offset:9216
    v_mfma_f32_16x16x32_bf16 v[140:143], v[16:19], v[44:47], v[140:143]
    s_cmp_eq_u32 s40, 2
    s_cselect_b32 s38, -2, 1
    s_lshl_b32 s39, s38, 14
    s_lshl_b32 s30, s38, 13
    v_mfma_f32_16x16x32_bf16 v[144:147], v[20:23], v[44:47], v[144:147]
    v_add_u32 v86, s30, v86
    v_add_u32 v87, s30, v87
    v_add_u32 v88, s39, v88
    v_mfma_f32_16x16x32_bf16 v[148:151], v[24:27], v[44:47], v[148:151]
    v_add_u32 v89, s39, v89
    v_add_u32 v90, s39, v90
    v_add_u32 v91, s39, v91
    v_mfma_f32_16x16x32_bf16 v[152:155], v[28:31], v[44:47], v[152:155]
    s_waitcnt vmcnt(0) lgkmcnt(0)
    s_barrier
    v_mfma_f32_16x16x32_bf16 v[92:95], v[64:67], v[48:51], v[92:95]
    ds_read_b128 v[16:19], v86 offset:0
    v_mfma_f32_16x16x32_bf16 v[96:99], v[64:67], v[52:55], v[96:99]
    ds_read_b64_tr_b16 v[32:33], v88 offset:0
    v_mfma_f32_16x16x32_bf16 v[108:111], v[48:51], v[68:71], v[108:111]
    ds_read_b64_tr_b16 v[34:35], v88 offset:1024
    v_mfma_f32_16x16x32_bf16 v[112:115], v[52:55], v[68:71], v[112:115]
    ds_read_b128 v[20:23], v86 offset:2048
    v_mfma_f32_16x16x32_bf16 v[100:103], v[64:67], v[56:59], v[100:103]
    ds_read_b64_tr_b16 v[36:37], v89 offset:0
    v_mfma_f32_16x16x32_bf16 v[116:119], v[56:59], v[68:71], v[116:119]
    ds_read_b64_tr_b16 v[38:39], v89 offset:1024
    v_mfma_f32_16x16x32_bf16 v[124:127], v[48:51], v[72:75], v[124:127]
    ds_read_b128 v[24:27], v86 offset:4096
    v_mfma_f32_16x16x32_bf16 v[128:131], v[52:55], v[72:75], v[128:131]
    ds_read_b64_tr_b16 v[40:41], v90 offset:0
    v_mfma_f32_16x16x32_bf16 v[132:135], v[56:59], v[72:75], v[132:135]
    ds_read_b64_tr_b16 v[42:43], v90 offset:1024
    v_mfma_f32_16x16x32_bf16 v[104:107], v[64:67], v[60:63], v[104:107]
    ds_read_b128 v[28:31], v86 offset:6144
    v_mfma_f32_16x16x32_bf16 v[120:123], v[60:63], v[68:71], v[120:123]
    ds_read_b64_tr_b16 v[44:45], v91 offset:0
    v_mfma_f32_16x16x32_bf16 v[136:139], v[60:63], v[72:75], v[136:139]
    ds_read_b64_tr_b16 v[46:47], v91 offset:1024
    v_mfma_f32_16x16x32_bf16 v[140:143], v[48:51], v[76:79], v[140:143]
    s_add_u32 s40, s40, s38
    s_and_b32 s31, s2, -8
    s_add_u32 s31, s31, s26
    v_mfma_f32_16x16x32_bf16 v[144:147], v[52:55], v[76:79], v[144:147]
    s_mul_i32 s31, s31, 3200
    v_min_u32 v255, 24, v1
    v_lshl_add_u32 v255, v255, 7, s31
    v_mfma_f32_16x16x32_bf16 v[148:151], v[56:59], v[76:79], v[148:151]
    s_lshl_b32 s31, s23, 1
    s_add_u32 s31, s31, s29
    s_lshl_b32 s31, s31, 3
    v_mfma_f32_16x16x32_bf16 v[152:155], v[60:63], v[76:79], v[152:155]
    s_add_u32 s43, s31, s52
    s_and_b32 s32, s24, 7
    s_mul_i32 s32, s32, 160
    s_sub_u32 s18, 819200, s32
    s_add_u32 s16, s56, s32
    s_addc_u32 s17, s57, 0
    s_mov_b32 s14, 5242880
    s_mov_b64 s[12:13], s[58:59]
    s_waitcnt lgkmcnt(0)
    v_mfma_f32_16x16x32_bf16 v[92:95], v[32:35], v[16:19], v[92:95]
    ds_read_b128 v[48:51], v87 offset:0
    v_mfma_f32_16x16x32_bf16 v[96:99], v[32:35], v[20:23], v[96:99]
    ds_read_b64_tr_b16 v[64:65], v88 offset:8192
    v_mfma_f32_16x16x32_bf16 v[108:111], v[16:19], v[36:39], v[108:111]
    ds_read_b64_tr_b16 v[66:67], v88 offset:9216
    v_mfma_f32_16x16x32_bf16 v[112:115], v[20:23], v[36:39], v[112:115]
    ds_read_b128 v[52:55], v87 offset:2048
    v_mfma_f32_16x16x32_bf16 v[100:103], v[32:35], v[24:27], v[100:103]
    ds_read_b64_tr_b16 v[68:69], v89 offset:8192
    v_mfma_f32_16x16x32_bf16 v[116:119], v[24:27], v[36:39], v[116:119]
    ds_read_b64_tr_b16 v[70:71], v89 offset:9216
    v_mfma_f32_16x16x32_bf16 v[124:127], v[16:19], v[40:43], v[124:127]
    ds_read_b128 v[56:59], v87 offset:4096
    v_mfma_f32_16x16x32_bf16 v[128:131], v[20:23], v[40:43], v[128:131]
    ds_read_b64_tr_b16 v[72:73], v90 offset:8192
    v_mfma_f32_16x16x32_bf16 v[132:135], v[24:27], v[40:43], v[132:135]
    ds_read_b64_tr_b16 v[74:75], v90 offset:9216
    v_mfma_f32_16x16x32_bf16 v[104:107], v[32:35], v[28:31], v[104:107]
    ds_read_b128 v[60:63], v87 offset:6144
    v_mfma_f32_16x16x32_bf16 v[120:123], v[28:31], v[36:39], v[120:123]
    ds_read_b64_tr_b16 v[76:77], v91 offset:8192
    v_mfma_f32_16x16x32_bf16 v[136:139], v[28:31], v[40:43], v[136:139]
    ds_read_b64_tr_b16 v[78:79], v91 offset:9216
    v_mfma_f32_16x16x32_bf16 v[140:143], v[16:19], v[44:47], v[140:143]
    v_readfirstlane_b32 s21, v253
    v_readfirstlane_b32 s20, v252
    s_add_u32 s31, s51, 3072
    v_mfma_f32_16x16x32_bf16 v[144:147], v[20:23], v[44:47], v[144:147]
    s_mov_b32 s46, 0xff00ff00
    s_mov_b32 s47, s46
    s_cmp_eq_u32 s21, 0
    s_cbranch_scc1 L_nonce1
L_nonce_ok1:
    v_mfma_f32_16x16x32_bf16 v[148:151], v[24:27], v[44:47], v[148:151]
    v_mfma_f32_16x16x32_bf16 v[152:155], v[28:31], v[44:47], v[152:155]
    s_waitcnt lgkmcnt(0)
    s_barrier
    v_mfma_f32_16x16x32_bf16 v[108:111], v[48:51], v[68:71], v[108:111]
    v_mfma_f32_16x16x32_bf16 v[112:115], v[52:55], v[68:71], v[112:115]
    ds_write_b128 v3, v[156:159] offset:0
    v_mfma_f32_16x16x32_bf16 v[116:119], v[56:59], v[68:71], v[116:119]
    v_mfma_f32_16x16x32_bf16 v[120:123], v[60:63], v[68:71], v[120:123]
    v_mfma_f32_16x16x32_bf16 v[124:127], v[48:51], v[72:75], v[124:127]
    v_mfma_f32_16x16x32_bf16 v[128:131], v[52:55], v[72:75], v[128:131]
    v_mfma_f32_16x16x32_bf16 v[132:135], v[56:59], v[72:75], v[132:135]
    v_mfma_f32_16x16x32_bf16 v[136:139], v[60:63], v[72:75], v[136:139]
    s_nop 0
    v_cvt_pk_bf16_f32 v16, v108, v109
    v_cvt_pk_bf16_f32 v17, v110, v111
    v_cvt_pk_bf16_f32 v18, v112, v113
    v_cvt_pk_bf16_f32 v19, v114, v115
    ds_write_b128 v246, v[16:19] offset:0
    v_mfma_f32_16x16x32_bf16 v[140:143], v[48:51], v[76:79], v[140:143]
    v_mfma_f32_16x16x32_bf16 v[144:147], v[52:55], v[76:79], v[144:147]
    v_cvt_pk_bf16_f32 v20, v116, v117
    v_cvt_pk_bf16_f32 v21, v118, v119
    v_cvt_pk_bf16_f32 v22, v120, v121
    v_cvt_pk_bf16_f32 v23, v122, v123
    ds_write_b128 v246, v[20:23] offset:3072
    v_mfma_f32_16x16x32_bf16 v[148:151], v[56:59], v[76:79], v[148:151]
    v_mfma_f32_16x16x32_bf16 v[152:155], v[60:63], v[76:79], v[152:155]
    v_cvt_pk_bf16_f32 v24, v124, v125
    v_cvt_pk_bf16_f32 v25, v126, v127
    v_cvt_pk_bf16_f32 v26, v128, v129
    v_cvt_pk_bf16_f32 v27, v130, v131
    ds_write_b128 v246, v[24:27] offset:1024
    v_mfma_f32_16x16x32_bf16 v[92:95], v[64:67], v[48:51], v[92:95]
    v_mfma_f32_16x16x32_bf16 v[100:103], v[64:67], v[56:59], v[100:103]
    v_cvt_pk_bf16_f32 v28, v132, v133
    v_cvt_pk_bf16_f32 v29, v134, v135
    v_cvt_pk_bf16_f32 v30, v136, v137
    v_cvt_pk_bf16_f32 v31, v138, v139
    ds_write_b128 v246, v[28:31] offset:4096
    v_mfma_f32_16x16x32_bf16 v[96:99], v[64:67], v[52:55], v[96:99]
    v_mfma_f32_16x16x32_bf16 v[104:107], v[64:67], v[60:63], v[104:107]
    v_cvt_pk_bf16_f32 v32, v140, v141
    v_cvt_pk_bf16_f32 v33, v142, v143
    v_cvt_pk_bf16_f32 v34, v144, v145
    v_cvt_pk_bf16_f32 v35, v146, v147
    v_cndmask_b32 v32, v32, v249, s[46:47]
    v_cndmask_b32 v33, v33, v249, s[46:47]
    v_cndmask_b32 v34, v34, v249, s[46:47]
    v_cndmask_b32 v35, v35, v249, s[46:47]
    ds_write_b128 v246, v[32:35] offset:2048
    v_cvt_pk_bf16_f32 v36, v148, v149
    v_cvt_pk_bf16_f32 v37, v150, v151
    v_cvt_pk_bf16_f32 v38, v152, v153
    v_cvt_pk_bf16_f32 v39, v154, v155
    v_cndmask_b32 v36, v36, v249, s[46:47]
    v_cndmask_b32 v37, v37, v249, s[46:47]
    v_cndmask_b32 v38, v38, v249, s[46:47]
    v_cndmask_b32 v39, v39, v249, s[46:47]
    ds_write_b128 v246, v[36:39] offset:5120
    v_pk_mul_f32 v[92:93], v[92:93], v[248:249] op_sel_hi:[1,0]
    v_pk_mul_f32 v[94:95], v[94:95], v[248:249] op_sel_hi:[1,0]
    v_pk_mul_f32 v[100:101], v[100:101], v[248:249] op_sel_hi:[1,0]
    v_pk_mul_f32 v[102:103], v[102:103], v[248:249] op_sel_hi:[1,0]
    v_cvt_pk_bf16_f32 v40, v92, v93
    v_cvt_pk_bf16_f32 v41, v94, v95
    v_cvt_pk_bf16_f32 v42, v100, v101
    v_cvt_pk_bf16_f32 v43, v102, v103
    ds_write_b128 v245, v[40:43] offset:4096
    v_pk_mul_f32 v[96:97], v[96:97], v[248:249] op_sel_hi:[1,0]
    v_pk_mul_f32 v[98:99], v[98:99], v[248:249] op_sel_hi:[1,0]
    v_pk_mul_f32 v[104:105], v[104:105], v[248:249] op_sel_hi:[1,0]
    v_pk_mul_f32 v[106:107], v[106:107], v[248:249] op_sel_hi:[1,0]
    v_cvt_pk_bf16_f32 v44, v96, v97
    v_cvt_pk_bf16_f32 v45, v98, v99
    v_cvt_pk_bf16_f32 v46, v104, v105
    v_cvt_pk_bf16_f32 v47, v106, v107
    ds_write_b128 v245, v[44:47] offset:5120
    buffer_store_dwordx4 v[16:19], v244, s[8:11], s51 offen offset:0 sc1
    buffer_store_dwordx4 v[20:23], v244, s[8:11], s31 offen offset:0 sc1
    s_setprio 3
    s_waitcnt lgkmcnt(0)
    s_barrier
    buffer_store_dwordx4 v[24:27], v244, s[8:11], s51 offen offset:1024 sc1
    buffer_store_dwordx4 v[28:31], v244, s[8:11], s31 offen offset:1024 sc1
    buffer_store_dwordx4 v[32:35], v244, s[8:11], s51 offen offset:2048 sc1
    buffer_store_dwordx4 v[36:39], v244, s[8:11], s31 offen offset:2048 sc1
    buffer_store_dwordx2 v[40:41], v243, s[8:11], s51 offen offset:0 sc1
    buffer_store_dwordx2 v[42:43], v243, s[8:11], s51 offen offset:1024 sc1
    buffer_store_dwordx2 v[44:45], v243, s[8:11], s51 offen offset:512 sc1
    buffer_store_dwordx2 v[46:47], v243, s[8:11], s51 offen offset:1536 sc1
L_epi_done:
    ds_read_b128 v[64:67], v247 offset:1024
    ds_read_b128 v[72:75], v250 offset:5632
    v_xor_b32 v4, 49152, v247
    ds_read_b128 v[16:19], v4 offset:13312
    ds_read_b128 v[20:23], v4 offset:15360
    v_lshrrev_b32 v5, 2, v1
    v_and_b32 v5, 8, v5
    v_add_u32 v250, v250, v5
    v_xor_b32 v5, 49152, v250
    v_xor_b32 v6, 32768, v250
    v_xor_b32 v7, 16384, v250
    ds_read_b64 v[48:49], v5 offset:5120
    ds_read_b64 v[50:51], v6 offset:5120
    ds_read_b64 v[52:53], v7 offset:5120
    ds_read_b64 v[54:55], v250 offset:5120
    v_xor_b32 v4, 32768, v247
    ds_read_b128 v[24:27], v4 offset:13312
    ds_read_b128 v[28:31], v4 offset:15360
    ds_read_b128 v[76:79], v251 offset:1024
    ds_read_b128 v[80:83], v251 offset:1536
    s_waitcnt lgkmcnt(7)
    v_mfma_f32_32x32x4_2b_bf16 v[92:123], v[72:73], v[48:49], 0
    v_xor_b32 v4, 16384, v247
    ds_read_b128 v[32:35], v4 offset:13312
    ds_read_b128 v[36:39], v4 offset:15360
    ds_read_b128 v[40:43], v247 offset:13312
    ds_read_b128 v[44:47], v247 offset:15360
    ds_read_b128 v[68:71], v247 offset:3072
    ds_read_b128 v[84:87], v251 offset:4096
    ds_read_b128 v[88:91], v251 offset:4608
    v_mov_b32 v5, 1
    ds_write_b32 v3, v5 offset:12
    v_mov_b32 v243, 0
    v_mov_b32 v244, 0
    v_mov_b32 v245, 0
    v_mov_b32 v246, 0
    v_mov_b32 v247, 0
    v_mov_b32 v248, 0
    v_mov_b32 v249, 0
    v_mov_b32 v250, 0
    v_mov_b32 v251, 0
    v_mfma_f32_32x32x16_bf16 v[92:107], v[64:67], v[16:19], v[92:107]
    v_mfma_f32_32x32x16_bf16 v[108:123], v[64:67], v[20:23], v[108:123]
    s_nop 8
    s_cmp_eq_u32 s29, 0
    s_cbranch_scc1 L_nosig
    s_waitcnt vmcnt(0)
    s_mov_b64 exec, 1
    buffer_atomic_swap_x2 v[252:253], off, s[8:11], s43 sc1
    s_mov_b64 exec, -1
    global_load_dword v255, v255, s[56:57]
L_nosig:
    v_exp_f32 v92, v92
    v_exp_f32 v93, v93
    v_exp_f32 v94, v94
    v_exp_f32 v95, v95
    v_exp_f32 v96, v96
    v_exp_f32 v97, v97
    s_waitcnt lgkmcnt(0)
    v_mfma_f32_32x32x4_2b_bf16 v[124:155], v[72:73], v[50:51], 0
    v_exp_f32 v98, v98
    v_exp_f32 v99, v99
    v_exp_f32 v100, v100
    v_exp_f32 v101, v101
    v_exp_f32 v102, v102
    v_exp_f32 v103, v103
    v_exp_f32 v104, v104
    v_exp_f32 v105, v105
    v_exp_f32 v106, v106
    v_exp_f32 v107, v107
    v_smfmac_f32_32x32x32_bf16 v[156:171], v[76:79], v[92:99], v11
    v_exp_f32 v108, v108
    v_exp_f32 v109, v109
    v_exp_f32 v110, v110
    v_smfmac_f32_32x32x32_bf16 v[156:171], v[80:83], v[100:107], v11
    v_exp_f32 v111, v111
    v_exp_f32 v112, v112
    v_exp_f32 v113, v113
    v_mfma_f32_32x32x16_bf16 v[124:139], v[64:67], v[24:27], v[124:139]
    v_exp_f32 v114, v114
    v_exp_f32 v115, v115
    v_exp_f32 v116, v116
    v_mfma_f32_32x32x16_bf16 v[140:155], v[64:67], v[28:31], v[140:155]
    v_exp_f32 v117, v117
    v_exp_f32 v118, v118
    v_exp_f32 v119, v119
    v_exp_f32 v120, v120
    v_exp_f32 v121, v121
    v_exp_f32 v122, v122
    v_exp_f32 v123, v123
    v_smfmac_f32_32x32x32_bf16 v[168:183], v[76:79], v[108:115], v11
    v_exp_f32 v124, v124
    v_exp_f32 v125, v125
    v_exp_f32 v126, v126
    v_smfmac_f32_32x32x32_bf16 v[168:183], v[80:83], v[116:123], v11
    v_exp_f32 v127, v127
    v_exp_f32 v128, v128
    v_exp_f32 v129, v129
    v_mfma_f32_32x32x4_2b_bf16 v[92:123], v[72:73], v[52:53], 0
    v_exp_f32 v130, v130
    v_exp_f32 v131, v131
    v_exp_f32 v132, v132
    v_exp_f32 v133, v133
    v_exp_f32 v134, v134
    v_exp_f32 v135, v135
    v_exp_f32 v136, v136
    v_exp_f32 v137, v137
    v_exp_f32 v138, v138
    v_exp_f32 v139, v139
    s_cmp_eq_u32 s29, 0
    s_cbranch_scc0 L_nosig2
    s_waitcnt vmcnt(0)
    s_mov_b64 exec, 1
    buffer_atomic_swap_x2 v[252:253], off, s[8:11], s43 sc1
    s_mov_b64 exec, -1
    global_load_dword v255, v255, s[56:57]
L_nosig2:
    v_smfmac_f32_32x32x32_bf16 v[180:195], v[76:79], v[124:131], v11
    v_exp_f32 v140, v140
    v_exp_f32 v141, v141
    v_exp_f32 v142, v142
    v_smfmac_f32_32x32x32_bf16 v[180:195], v[80:83], v[132:139], v11
    v_exp_f32 v143, v143
    v_exp_f32 v144, v144
    v_exp_f32 v145, v145
    v_mfma_f32_32x32x16_bf16 v[92:107], v[64:67], v[32:35], v[92:107]
    v_exp_f32 v146, v146
    v_exp_f32 v147, v147
    v_exp_f32 v148, v148
    v_mfma_f32_32x32x16_bf16 v[108:123], v[64:67], v[36:39], v[108:123]
    v_exp_f32 v149, v149
    v_exp_f32 v150, v150
    v_exp_f32 v151, v151
    v_exp_f32 v152, v152
    v_exp_f32 v153, v153
    v_exp_f32 v154, v154
    v_exp_f32 v155, v155
    v_smfmac_f32_32x32x32_bf16 v[192:207], v[76:79], v[140:147], v11
    v_exp_f32 v92, v92
    v_exp_f32 v93, v93
    v_exp_f32 v94, v94
    v_smfmac_f32_32x32x32_bf16 v[192:207], v[80:83], v[148:155], v11
    v_exp_f32 v95, v95
    v_exp_f32 v96, v96
    v_exp_f32 v97, v97
    v_mfma_f32_32x32x4_2b_bf16 v[124:155], v[72:73], v[54:55], 0
    v_exp_f32 v98, v98
    v_exp_f32 v99, v99
    v_exp_f32 v100, v100
    v_exp_f32 v101, v101
    v_exp_f32 v102, v102
    v_exp_f32 v103, v103
    v_exp_f32 v104, v104
    v_exp_f32 v105, v105
    v_exp_f32 v106, v106
    v_exp_f32 v107, v107
    s_cmp_eq_u32 s29, 0
    s_cbranch_scc1 L_nosig3
    s_setprio 1
L_nosig3:
    v_smfmac_f32_32x32x32_bf16 v[204:219], v[76:79], v[92:99], v11
    v_exp_f32 v108, v108
    v_exp_f32 v109, v109
    v_exp_f32 v110, v110
    v_smfmac_f32_32x32x32_bf16 v[204:219], v[80:83], v[100:107], v11
    v_exp_f32 v111, v111
    v_exp_f32 v112, v112
    v_exp_f32 v113, v113
    v_mfma_f32_32x32x16_bf16 v[124:139], v[64:67], v[40:43], v[124:139]
    v_exp_f32 v114, v114
    v_exp_f32 v115, v115
    v_exp_f32 v116, v116
    v_mfma_f32_32x32x16_bf16 v[140:155], v[64:67], v[44:47], v[140:155]
    v_exp_f32 v117, v117
    v_exp_f32 v118, v118
    v_exp_f32 v119, v119
    v_exp_f32 v120, v120
    v_exp_f32 v121, v121
    v_exp_f32 v122, v122
    v_exp_f32 v123, v123
    v_smfmac_f32_32x32x32_bf16 v[216:231], v[76:79], v[108:115], v11
    v_exp_f32 v124, v124
    v_exp_f32 v125, v125
    v_exp_f32 v126, v126
    v_smfmac_f32_32x32x32_bf16 v[216:231], v[80:83], v[116:123], v11
    v_exp_f32 v127, v127
    v_exp_f32 v128, v128
    v_exp_f32 v129, v129
    v_mfma_f32_32x32x4_2b_bf16 v[92:123], v[74:75], v[48:49], 0
    v_exp_f32 v130, v130
    v_exp_f32 v131, v131
    v_exp_f32 v132, v132
    v_exp_f32 v133, v133
    v_exp_f32 v134, v134
    v_exp_f32 v135, v135
    v_exp_f32 v136, v136
    v_exp_f32 v137, v137
    v_exp_f32 v138, v138
    v_exp_f32 v139, v139
    v_smfmac_f32_32x32x32_bf16 v[228:243], v[76:79], v[124:131], v11
    v_exp_f32 v140, v140
    v_exp_f32 v141, v141
    v_exp_f32 v142, v142
    v_smfmac_f32_32x32x32_bf16 v[228:243], v[80:83], v[132:139], v11
    v_exp_f32 v143, v143
    v_exp_f32 v144, v144
    v_exp_f32 v145, v145
    v_mfma_f32_32x32x16_bf16 v[92:107], v[68:71], v[16:19], v[92:107]
    v_exp_f32 v146, v146
    v_exp_f32 v147, v147
    v_exp_f32 v148, v148
    v_mfma_f32_32x32x16_bf16 v[108:123], v[68:71], v[20:23], v[108:123]
    v_exp_f32 v149, v149
    v_exp_f32 v150, v150
    v_exp_f32 v151, v151
    v_exp_f32 v152, v152
    v_exp_f32 v153, v153
    v_exp_f32 v154, v154
    v_exp_f32 v155, v155
    v_smfmac_f32_32x32x32_bf16 v[240:255], v[76:79], v[140:147], v11
    v_exp_f32 v92, v92
    v_exp_f32 v93, v93
    v_exp_f32 v94, v94
    v_smfmac_f32_32x32x32_bf16 v[240:255], v[80:83], v[148:155], v11
    v_exp_f32 v95, v95
    v_exp_f32 v96, v96
    v_exp_f32 v97, v97
    v_mfma_f32_32x32x4_2b_bf16 v[124:155], v[74:75], v[50:51], 0
    v_exp_f32 v98, v98
    v_exp_f32 v99, v99
    v_exp_f32 v100, v100
    v_exp_f32 v101, v101
    v_exp_f32 v102, v102
    v_exp_f32 v103, v103
    v_exp_f32 v104, v104
    v_exp_f32 v105, v105
    v_exp_f32 v106, v106
    v_exp_f32 v107, v107
    v_smfmac_f32_32x32x32_bf16 v[156:171], v[84:87], v[92:99], v11
    v_exp_f32 v108, v108
    v_exp_f32 v109, v109
    v_exp_f32 v110, v110
    v_smfmac_f32_32x32x32_bf16 v[156:171], v[88:91], v[100:107], v11
    v_exp_f32 v111, v111
    v_exp_f32 v112, v112
    v_exp_f32 v113, v113
    v_mfma_f32_32x32x16_bf16 v[124:139], v[68:71], v[24:27], v[124:139]
    v_exp_f32 v114, v114
    v_exp_f32 v115, v115
    v_exp_f32 v116, v116
    v_mfma_f32_32x32x16_bf16 v[140:155], v[68:71], v[28:31], v[140:155]
    v_exp_f32 v117, v117
    v_exp_f32 v118, v118
    v_exp_f32 v119, v119
    v_exp_f32 v120, v120
    v_exp_f32 v121, v121
    v_exp_f32 v122, v122
    v_exp_f32 v123, v123
    v_smfmac_f32_32x32x32_bf16 v[168:183], v[84:87], v[108:115], v11
    v_exp_f32 v124, v124
    v_exp_f32 v125, v125
    v_exp_f32 v126, v126
    v_smfmac_f32_32x32x32_bf16 v[168:183], v[88:91], v[116:123], v11
    v_exp_f32 v127, v127
    v_exp_f32 v128, v128
    v_exp_f32 v129, v129
    v_mfma_f32_32x32x4_2b_bf16 v[92:123], v[74:75], v[52:53], 0
    v_exp_f32 v130, v130
    v_exp_f32 v131, v131
    v_exp_f32 v132, v132
    v_exp_f32 v133, v133
    v_exp_f32 v134, v134
    v_exp_f32 v135, v135
    v_exp_f32 v136, v136
    v_exp_f32 v137, v137
    v_exp_f32 v138, v138
    v_exp_f32 v139, v139
    v_smfmac_f32_32x32x32_bf16 v[180:195], v[84:87], v[124:131], v11
    v_exp_f32 v140, v140
    v_exp_f32 v141, v141
    v_exp_f32 v142, v142
    v_smfmac_f32_32x32x32_bf16 v[180:195], v[88:91], v[132:139], v11
    v_exp_f32 v143, v143
    v_exp_f32 v144, v144
    v_exp_f32 v145, v145
    v_mfma_f32_32x32x16_bf16 v[92:107], v[68:71], v[32:35], v[92:107]
    v_exp_f32 v146, v146
    v_exp_f32 v147, v147
    v_exp_f32 v148, v148
    v_mfma_f32_32x32x16_bf16 v[108:123], v[68:71], v[36:39], v[108:123]
    v_exp_f32 v149, v149
    v_exp_f32 v150, v150
    v_exp_f32 v151, v151
    v_exp_f32 v152, v152
    v_exp_f32 v153, v153
    v_exp_f32 v154, v154
    v_exp_f32 v155, v155
    s_mov_b32 s36, 0
    s_lshl_b32 s37, s26, 10
    s_add_u32 s37, s37, 1024
    s_mov_b32 s42, 71680
    s_mov_b32 s44, 5120
    s_mov_b32 s45, 30720
    s_mov_b32 s3, 40960
    s_mov_b32 s34, 0
    s_cmp_lt_u32 s26, 5
    s_cbranch_scc1 L_wos
    s_lshl_b32 s37, s26, 11
    s_add_u32 s37, s37, 72704
    s_mov_b32 s42, 5120
    s_mov_b32 s34, 407552
    s_mov_b32 s45, 0
    s_cmp_eq_u32 s26, 7
    s_cselect_b32 s3, 0, 1024
L_wos:
    v_and_b32 v6, 7, v1
    v_lshlrev_b32 v6, 5, v6
    s_mov_b32 s38, 0
L_img:
    ds_read_b32 v5, v6 offset:12
    s_add_u32 s38, s38, 1
    s_waitcnt lgkmcnt(0)
    v_cmp_le_u32 vcc, 1, v5
    s_cmp_gt_u32 s38, 0x20000
    s_cbranch_scc1 L_img_ok
    s_cmp_eq_u64 vcc, -1
    s_cbranch_scc1 L_img_ok
    s_sleep 2
    s_branch L_img
L_img_ok:
    s_mov_b32 s38, 0
L_poll1:
    v_mov_b32 v4, 0
    v_mov_b32 v5, 0
    buffer_atomic_or_x2 v[4:5], v12, s[8:11], s52 offen sc0 sc1
    s_add_u32 s38, s38, 1
    s_waitcnt vmcnt(0)
    v_cmp_eq_u64 vcc, s[20:21], v[4:5]
    s_cmp_gt_u32 s38, 0x4000
    s_cbranch_scc1 L_poll1_ok
    s_andn2_b32 s30, s55, vcc_lo
    s_cbranch_scc0 L_poll1_ok
    s_sleep 2
    s_branch L_poll1
L_poll1_ok:
    s_andn2_b32 s55, 0xffff, vcc_lo
    s_mov_b32 s35, 0
    s_add_u32 s35, s35, 1
    s_xor_b32 s33, s35, s23
    s_and_b32 s33, s33, 7
    s_mul_i32 s33, s33, 49152
    s_add_u32 s33, s33, s50
    s_mov_b32 m0, s37
    s_nop 0
    buffer_load_dwordx4 v0, s[16:19], s36 offen lds
    s_add_u32 m0, s37, s3
    s_add_u32 s36, s36, s45
    buffer_load_dwordx4 v2, s[16:19], s36 offen lds
    s_add_u32 s36, s36, s42
    s_add_u32 s37, s37, s44
    s_xor_b32 s42, s42, s34
    buffer_load_dwordx4 v[64:67], v8, s[8:11], s33 offen offset:0 sc1
    buffer_load_dwordx2 v[72:73], v9, s[8:11], s33 offen offset:0 sc1
    buffer_load_dwordx4 v[76:79], v10, s[8:11], s33 offen offset:0 sc1
    buffer_load_dwordx4 v[80:83], v10, s[8:11], s33 offen offset:512 sc1
    v_smfmac_f32_32x32x32_bf16 v[192:207], v[84:87], v[140:147], v11
    v_exp_f32 v92, v92
    v_exp_f32 v93, v93
    v_exp_f32 v94, v94
    v_smfmac_f32_32x32x32_bf16 v[192:207], v[88:91], v[148:155], v11
    v_exp_f32 v95, v95
    v_exp_f32 v96, v96
    v_exp_f32 v97, v97
    v_mfma_f32_32x32x4_2b_bf16 v[124:155], v[74:75], v[54:55], 0
    v_exp_f32 v98, v98
    v_exp_f32 v99, v99
    v_exp_f32 v100, v100
    v_exp_f32 v101, v101
    v_exp_f32 v102, v102
    v_exp_f32 v103, v103
    v_exp_f32 v104, v104
    v_exp_f32 v105, v105
    v_exp_f32 v106, v106
    v_exp_f32 v107, v107
    v_smfmac_f32_32x32x32_bf16 v[204:219], v[84:87], v[92:99], v11
    v_exp_f32 v108, v108
    v_exp_f32 v109, v109
    v_exp_f32 v110, v110
    v_smfmac_f32_32x32x32_bf16 v[204:219], v[88:91], v[100:107], v11
    v_exp_f32 v111, v111
    v_exp_f32 v112, v112
    v_exp_f32 v113, v113
    v_mfma_f32_32x32x16_bf16 v[124:139], v[68:71], v[40:43], v[124:139]
    v_exp_f32 v114, v114
    v_exp_f32 v115, v115
    v_exp_f32 v116, v116
    v_mfma_f32_32x32x16_bf16 v[140:155], v[68:71], v[44:47], v[140:155]
    v_exp_f32 v117, v117
    v_exp_f32 v118, v118
    v_exp_f32 v119, v119
    v_exp_f32 v120, v120
    v_exp_f32 v121, v121
    v_exp_f32 v122, v122
    v_exp_f32 v123, v123
    v_smfmac_f32_32x32x32_bf16 v[216:231], v[84:87], v[108:115], v11
    s_waitcnt vmcnt(2)
    buffer_load_dwordx4 v[68:71], v8, s[8:11], s33 offen offset:2048 sc1
    v_exp_f32 v124, v124
    v_exp_f32 v125, v125
    v_exp_f32 v126, v126
    v_smfmac_f32_32x32x32_bf16 v[216:231], v[88:91], v[116:123], v11
    buffer_load_dwordx2 v[74:75], v9, s[8:11], s33 offen offset:1024 sc1
    v_exp_f32 v127, v127
    v_exp_f32 v128, v128
    v_exp_f32 v129, v129
    v_mfma_f32_32x32x4_2b_bf16 v[92:123], v[72:73], v[48:49], 0
    v_exp_f32 v130, v130
    v_exp_f32 v131, v131
    v_exp_f32 v132, v132
    v_exp_f32 v133, v133
    v_exp_f32 v134, v134
    v_exp_f32 v135, v135
    v_exp_f32 v136, v136
    v_exp_f32 v137, v137
    v_exp_f32 v138, v138
    v_exp_f32 v139, v139
    v_smfmac_f32_32x32x32_bf16 v[228:243], v[84:87], v[124:131], v11
    v_exp_f32 v140, v140
    v_exp_f32 v141, v141
    v_exp_f32 v142, v142
    v_smfmac_f32_32x32x32_bf16 v[228:243], v[88:91], v[132:139], v11
    v_exp_f32 v143, v143
    v_exp_f32 v144, v144
    v_exp_f32 v145, v145
    v_mfma_f32_32x32x16_bf16 v[92:107], v[64:67], v[16:19], v[92:107]
    v_exp_f32 v146, v146
    v_exp_f32 v147, v147
    v_exp_f32 v148, v148
    v_mfma_f32_32x32x16_bf16 v[108:123], v[64:67], v[20:23], v[108:123]
    v_exp_f32 v149, v149
    v_exp_f32 v150, v150
    v_exp_f32 v151, v151
    v_exp_f32 v152, v152
    v_exp_f32 v153, v153
    v_exp_f32 v154, v154
    v_exp_f32 v155, v155
    s_mov_b32 s43, 3
    s_cmp_eq_u32 s29, 0
    s_cbranch_scc1 L_nolead
    s_setprio 3
L_nolead:
.p2align 6
L_attn:
    s_cmp_eq_u32 s35, s43
    s_cbranch_scc1 L_mid
L_attn_go:
    v_smfmac_f32_32x32x32_bf16 v[240:255], v[84:87], v[140:147], v11
    v_exp_f32 v92, v92
    v_exp_f32 v93, v93
    v_exp_f32 v94, v94
    v_smfmac_f32_32x32x32_bf16 v[240:255], v[88:91], v[148:155], v11
    s_waitcnt vmcnt(2)
    v_exp_f32 v95, v95
    v_exp_f32 v96, v96
    v_exp_f32 v97, v97
    v_mfma_f32_32x32x4_2b_bf16 v[124:155], v[72:73], v[50:51], 0
    v_exp_f32 v98, v98
    v_exp_f32 v99, v99
    v_exp_f32 v100, v100
    v_exp_f32 v101, v101
    v_exp_f32 v102, v102
    v_exp_f32 v103, v103
    v_exp_f32 v104, v104
    v_exp_f32 v105, v105
    v_exp_f32 v106, v106
    v_exp_f32 v107, v107
    v_smfmac_f32_32x32x32_bf16 v[156:171], v[76:79], v[92:99], v11
    buffer_load_dwordx4 v[84:87], v10, s[8:11], s33 offen offset:3072 sc1
    v_exp_f32 v108, v108
    v_exp_f32 v109, v109
    v_exp_f32 v110, v110
    v_smfmac_f32_32x32x32_bf16 v[156:171], v[80:83], v[100:107], v11
    buffer_load_dwordx4 v[88:91], v10, s[8:11], s33 offen offset:3584 sc1
    v_exp_f32 v111, v111
    v_exp_f32 v112, v112
    v_exp_f32 v113, v113
    v_mfma_f32_32x32x16_bf16 v[124:139], v[64:67], v[24:27], v[124:139]
    v_exp_f32 v114, v114
    v_exp_f32 v115, v115
    v_exp_f32 v116, v116
    v_mfma_f32_32x32x16_bf16 v[140:155], v[64:67], v[28:31], v[140:155]
    v_exp_f32 v117, v117
    v_exp_f32 v118, v118
    v_exp_f32 v119, v119
    v_exp_f32 v120, v120
    v_exp_f32 v121, v121
    v_exp_f32 v122, v122
    v_exp_f32 v123, v123
    v_smfmac_f32_32x32x32_bf16 v[168:183], v[76:79], v[108:115], v11
    v_exp_f32 v124, v124
    v_exp_f32 v125, v125
    v_exp_f32 v126, v126
    v_smfmac_f32_32x32x32_bf16 v[168:183], v[80:83], v[116:123], v11
    s_mov_b32 m0, s37
    v_exp_f32 v127, v127
    v_exp_f32 v128, v128
    v_exp_f32 v129, v129
    v_mfma_f32_32x32x4_2b_bf16 v[92:123], v[72:73], v[52:53], 0
    v_exp_f32 v130, v130
    v_exp_f32 v131, v131
    v_exp_f32 v132, v132
    v_exp_f32 v133, v133
    v_exp_f32 v134, v134
    v_exp_f32 v135, v135
    v_exp_f32 v136, v136
    v_exp_f32 v137, v137
    v_exp_f32 v138, v138
    v_exp_f32 v139, v139
    v_smfmac_f32_32x32x32_bf16 v[180:195], v[76:79], v[124:131], v11
    buffer_load_dwordx4 v0, s[16:19], s36 offen lds
    v_exp_f32 v140, v140
    v_exp_f32 v141, v141
    v_exp_f32 v142, v142
    v_smfmac_f32_32x32x32_bf16 v[180:195], v[80:83], v[132:139], v11
    s_add_u32 m0, s37, s3
    s_add_u32 s36, s36, s45
    v_exp_f32 v143, v143
    v_exp_f32 v144, v144
    v_exp_f32 v145, v145
    v_mfma_f32_32x32x16_bf16 v[92:107], v[64:67], v[32:35], v[92:107]
    buffer_load_dwordx4 v2, s[16:19], s36 offen lds
    v_exp_f32 v146, v146
    v_exp_f32 v147, v147
    v_exp_f32 v148, v148
    v_mfma_f32_32x32x16_bf16 v[108:123], v[64:67], v[36:39], v[108:123]
    v_exp_f32 v149, v149
    v_exp_f32 v150, v150
    v_exp_f32 v151, v151
    v_exp_f32 v152, v152
    v_exp_f32 v153, v153
    v_exp_f32 v154, v154
    v_exp_f32 v155, v155
    v_smfmac_f32_32x32x32_bf16 v[192:207], v[76:79], v[140:147], v11
    s_add_u32 s35, s35, 1
    s_xor_b32 s33, s35, s23
    v_exp_f32 v92, v92
    v_exp_f32 v93, v93
    v_exp_f32 v94, v94
    v_smfmac_f32_32x32x32_bf16 v[192:207], v[80:83], v[148:155], v11
    s_and_b32 s33, s33, 7
    s_mul_i32 s33, s33, 49152
    v_exp_f32 v95, v95
    v_exp_f32 v96, v96
    v_exp_f32 v97, v97
    v_mfma_f32_32x32x4_2b_bf16 v[124:155], v[72:73], v[54:55], 0
    v_exp_f32 v98, v98
    v_exp_f32 v99, v99
    v_exp_f32 v100, v100
    v_exp_f32 v101, v101
    v_exp_f32 v102, v102
    v_exp_f32 v103, v103
    v_exp_f32 v104, v104
    v_exp_f32 v105, v105
    v_exp_f32 v106, v106
    v_exp_f32 v107, v107
    v_smfmac_f32_32x32x32_bf16 v[204:219], v[76:79], v[92:99], v11
    s_add_u32 s36, s36, s42
    s_add_u32 s37, s37, s44
    v_exp_f32 v108, v108
    v_exp_f32 v109, v109
    v_exp_f32 v110, v110
    v_smfmac_f32_32x32x32_bf16 v[204:219], v[80:83], v[100:107], v11
    s_xor_b32 s42, s42, s34
    v_exp_f32 v111, v111
    v_exp_f32 v112, v112
    v_exp_f32 v113, v113
    v_mfma_f32_32x32x16_bf16 v[124:139], v[64:67], v[40:43], v[124:139]
    s_add_u32 s33, s33, s50
    v_exp_f32 v114, v114
    v_exp_f32 v115, v115
    v_exp_f32 v116, v116
    v_mfma_f32_32x32x16_bf16 v[140:155], v[64:67], v[44:47], v[140:155]
    v_exp_f32 v117, v117
    v_exp_f32 v118, v118
    v_exp_f32 v119, v119
    v_exp_f32 v120, v120
    v_exp_f32 v121, v121
    v_exp_f32 v122, v122
    v_exp_f32 v123, v123
    v_smfmac_f32_32x32x32_bf16 v[216:231], v[76:79], v[108:115], v11
    s_waitcnt vmcnt(4)
    buffer_load_dwordx4 v[64:67], v8, s[8:11], s33 offen offset:0 sc1
    v_exp_f32 v124, v124
    v_exp_f32 v125, v125
    v_exp_f32 v126, v126
    v_smfmac_f32_32x32x32_bf16 v[216:231], v[80:83], v[116:123], v11
    buffer_load_dwordx2 v[72:73], v9, s[8:11], s33 offen offset:0 sc1
    v_exp_f32 v127, v127
    v_exp_f32 v128, v128
    v_exp_f32 v129, v129
    v_mfma_f32_32x32x4_2b_bf16 v[92:123], v[74:75], v[48:49], 0
    v_exp_f32 v130, v130
    v_exp_f32 v131, v131
    v_exp_f32 v132, v132
    v_exp_f32 v133, v133
    v_exp_f32 v134, v134
    v_exp_f32 v135, v135
    v_exp_f32 v136, v136
    v_exp_f32 v137, v137
    v_exp_f32 v138, v138
    v_exp_f32 v139, v139
    v_smfmac_f32_32x32x32_bf16 v[228:243], v[76:79], v[124:131], v11
    v_exp_f32 v140, v140
    v_exp_f32 v141, v141
    v_exp_f32 v142, v142
    v_smfmac_f32_32x32x32_bf16 v[228:243], v[80:83], v[132:139], v11
    v_exp_f32 v143, v143
    v_exp_f32 v144, v144
    v_exp_f32 v145, v145
    v_mfma_f32_32x32x16_bf16 v[92:107], v[68:71], v[16:19], v[92:107]
    v_exp_f32 v146, v146
    v_exp_f32 v147, v147
    v_exp_f32 v148, v148
    v_mfma_f32_32x32x16_bf16 v[108:123], v[68:71], v[20:23], v[108:123]
    v_exp_f32 v149, v149
    v_exp_f32 v150, v150
    v_exp_f32 v151, v151
    v_exp_f32 v152, v152
    v_exp_f32 v153, v153
    v_exp_f32 v154, v154
    v_exp_f32 v155, v155
    v_smfmac_f32_32x32x32_bf16 v[240:255], v[76:79], v[140:147], v11
    v_exp_f32 v92, v92
    v_exp_f32 v93, v93
    v_exp_f32 v94, v94
    v_smfmac_f32_32x32x32_bf16 v[240:255], v[80:83], v[148:155], v11
    s_waitcnt vmcnt(4)
    v_exp_f32 v95, v95
    v_exp_f32 v96, v96
    v_exp_f32 v97, v97
    v_mfma_f32_32x32x4_2b_bf16 v[124:155], v[74:75], v[50:51], 0
    v_exp_f32 v98, v98
    v_exp_f32 v99, v99
    v_exp_f32 v100, v100
    v_exp_f32 v101, v101
    v_exp_f32 v102, v102
    v_exp_f32 v103, v103
    v_exp_f32 v104, v104
    v_exp_f32 v105, v105
    v_exp_f32 v106, v106
    v_exp_f32 v107, v107
    v_smfmac_f32_32x32x32_bf16 v[156:171], v[84:87], v[92:99], v11
    buffer_load_dwordx4 v[76:79], v10, s[8:11], s33 offen offset:0 sc1
    v_exp_f32 v108, v108
    v_exp_f32 v109, v109
    v_exp_f32 v110, v110
    v_smfmac_f32_32x32x32_bf16 v[156:171], v[88:91], v[100:107], v11
    buffer_load_dwordx4 v[80:83], v10, s[8:11], s33 offen offset:512 sc1
    v_exp_f32 v111, v111
    v_exp_f32 v112, v112
    v_exp_f32 v113, v113
    v_mfma_f32_32x32x16_bf16 v[124:139], v[68:71], v[24:27], v[124:139]
    v_exp_f32 v114, v114
    v_exp_f32 v115, v115
    v_exp_f32 v116, v116
    v_mfma_f32_32x32x16_bf16 v[140:155], v[68:71], v[28:31], v[140:155]
    v_exp_f32 v117, v117
    v_exp_f32 v118, v118
    v_exp_f32 v119, v119
    v_exp_f32 v120, v120
    v_exp_f32 v121, v121
    v_exp_f32 v122, v122
    v_exp_f32 v123, v123
    v_smfmac_f32_32x32x32_bf16 v[168:183], v[84:87], v[108:115], v11
    v_exp_f32 v124, v124
    v_exp_f32 v125, v125
    v_exp_f32 v126, v126
    v_smfmac_f32_32x32x32_bf16 v[168:183], v[88:91], v[116:123], v11
    v_exp_f32 v127, v127
    v_exp_f32 v128, v128
    v_exp_f32 v129, v129
    v_mfma_f32_32x32x4_2b_bf16 v[92:123], v[74:75], v[52:53], 0
    v_exp_f32 v130, v130
    v_exp_f32 v131, v131
    v_exp_f32 v132, v132
    v_exp_f32 v133, v133
    v_exp_f32 v134, v134
    v_exp_f32 v135, v135
    v_exp_f32 v136, v136
    v_exp_f32 v137, v137
    v_exp_f32 v138, v138
    v_exp_f32 v139, v139
    v_smfmac_f32_32x32x32_bf16 v[180:195], v[84:87], v[124:131], v11
    v_exp_f32 v140, v140
    v_exp_f32 v141, v141
    v_exp_f32 v142, v142
    v_smfmac_f32_32x32x32_bf16 v[180:195], v[88:91], v[132:139], v11
    v_exp_f32 v143, v143
    v_exp_f32 v144, v144
    v_exp_f32 v145, v145
    v_mfma_f32_32x32x16_bf16 v[92:107], v[68:71], v[32:35], v[92:107]
    v_exp_f32 v146, v146
    v_exp_f32 v147, v147
    v_exp_f32 v148, v148
    v_mfma_f32_32x32x16_bf16 v[108:123], v[68:71], v[36:39], v[108:123]
    v_exp_f32 v149, v149
    v_exp_f32 v150, v150
    v_exp_f32 v151, v151
    v_exp_f32 v152, v152
    v_exp_f32 v153, v153
    v_exp_f32 v154, v154
    v_exp_f32 v155, v155
    v_smfmac_f32_32x32x32_bf16 v[192:207], v[84:87], v[140:147], v11
    v_exp_f32 v92, v92
    v_exp_f32 v93, v93
    v_exp_f32 v94, v94
    v_smfmac_f32_32x32x32_bf16 v[192:207], v[88:91], v[148:155], v11
    v_exp_f32 v95, v95
    v_exp_f32 v96, v96
    v_exp_f32 v97, v97
    v_mfma_f32_32x32x4_2b_bf16 v[124:155], v[74:75], v[54:55], 0
    v_exp_f32 v98, v98
    v_exp_f32 v99, v99
    v_exp_f32 v100, v100
    v_exp_f32 v101, v101
    v_exp_f32 v102, v102
    v_exp_f32 v103, v103
    v_exp_f32 v104, v104
    v_exp_f32 v105, v105
    v_exp_f32 v106, v106
    v_exp_f32 v107, v107
    v_smfmac_f32_32x32x32_bf16 v[204:219], v[84:87], v[92:99], v11
    v_exp_f32 v108, v108
    v_exp_f32 v109, v109
    v_exp_f32 v110, v110
    v_smfmac_f32_32x32x32_bf16 v[204:219], v[88:91], v[100:107], v11
    v_exp_f32 v111, v111
    v_exp_f32 v112, v112
    v_exp_f32 v113, v113
    v_mfma_f32_32x32x16_bf16 v[124:139], v[68:71], v[40:43], v[124:139]
    v_exp_f32 v114, v114
    v_exp_f32 v115, v115
    v_exp_f32 v116, v116
    v_mfma_f32_32x32x16_bf16 v[140:155], v[68:71], v[44:47], v[140:155]
    v_exp_f32 v117, v117
    v_exp_f32 v118, v118
    v_exp_f32 v119, v119
    v_exp_f32 v120, v120
    v_exp_f32 v121, v121
    v_exp_f32 v122, v122
    v_exp_f32 v123, v123
    v_smfmac_f32_32x32x32_bf16 v[216:231], v[84:87], v[108:115], v11
    s_waitcnt vmcnt(2)
    buffer_load_dwordx4 v[68:71], v8, s[8:11], s33 offen offset:2048 sc1
    v_exp_f32 v124, v124
    v_exp_f32 v125, v125
    v_exp_f32 v126, v126
    v_smfmac_f32_32x32x32_bf16 v[216:231], v[88:91], v[116:123], v11
    buffer_load_dwordx2 v[74:75], v9, s[8:11], s33 offen offset:1024 sc1
    v_exp_f32 v127, v127
    v_exp_f32 v128, v128
    v_exp_f32 v129, v129
    v_mfma_f32_32x32x4_2b_bf16 v[92:123], v[72:73], v[48:49], 0
    v_exp_f32 v130, v130
    v_exp_f32 v131, v131
    v_exp_f32 v132, v132
    v_exp_f32 v133, v133
    v_exp_f32 v134, v134
    v_exp_f32 v135, v135
    v_exp_f32 v136, v136
    v_exp_f32 v137, v137
    v_exp_f32 v138, v138
    v_exp_f32 v139, v139
    v_smfmac_f32_32x32x32_bf16 v[228:243], v[84:87], v[124:131], v11
    s_cmp_lt_u32 s35, 7
    v_exp_f32 v140, v140
    v_exp_f32 v141, v141
    v_exp_f32 v142, v142
    v_smfmac_f32_32x32x32_bf16 v[228:243], v[88:91], v[132:139], v11
    v_exp_f32 v143, v143
    v_exp_f32 v144, v144
    v_exp_f32 v145, v145
    v_mfma_f32_32x32x16_bf16 v[92:107], v[64:67], v[16:19], v[92:107]
    v_exp_f32 v146, v146
    v_exp_f32 v147, v147
    v_exp_f32 v148, v148
    v_mfma_f32_32x32x16_bf16 v[108:123], v[64:67], v[20:23], v[108:123]
    v_exp_f32 v149, v149
    v_exp_f32 v150, v150
    v_exp_f32 v151, v151
    v_exp_f32 v152, v152
    v_exp_f32 v153, v153
    v_exp_f32 v154, v154
    v_exp_f32 v155, v155
    s_cbranch_scc1 L_attn
    v_smfmac_f32_32x32x32_bf16 v[240:255], v[84:87], v[140:147], v11
    v_exp_f32 v92, v92
    v_exp_f32 v93, v93
    v_exp_f32 v94, v94
    v_smfmac_f32_32x32x32_bf16 v[240:255], v[88:91], v[148:155], v11
    s_waitcnt vmcnt(2)
    v_exp_f32 v95, v95
    v_exp_f32 v96, v96
    v_exp_f32 v97, v97
    v_mfma_f32_32x32x4_2b_bf16 v[124:155], v[72:73], v[50:51], 0
    v_exp_f32 v98, v98
    v_exp_f32 v99, v99
    v_exp_f32 v100, v100
    v_exp_f32 v101, v101
    v_exp_f32 v102, v102
    v_exp_f32 v103, v103
    v_exp_f32 v104, v104
    v_exp_f32 v105, v105
    v_exp_f32 v106, v106
    v_exp_f32 v107, v107
    v_smfmac_f32_32x32x32_bf16 v[156:171], v[76:79], v[92:99], v11
    buffer_load_dwordx4 v[84:87], v10, s[8:11], s33 offen offset:3072 sc1
    v_exp_f32 v108, v108
    v_exp_f32 v109, v109
    v_exp_f32 v110, v110
    v_smfmac_f32_32x32x32_bf16 v[156:171], v[80:83], v[100:107], v11
    buffer_load_dwordx4 v[88:91], v10, s[8:11], s33 offen offset:3584 sc1
    v_exp_f32 v111, v111
    v_exp_f32 v112, v112
    v_exp_f32 v113, v113
    v_mfma_f32_32x32x16_bf16 v[124:139], v[64:67], v[24:27], v[124:139]
    v_exp_f32 v114, v114
    v_exp_f32 v115, v115
    v_exp_f32 v116, v116
    v_mfma_f32_32x32x16_bf16 v[140:155], v[64:67], v[28:31], v[140:155]
    v_exp_f32 v117, v117
    v_exp_f32 v118, v118
    v_exp_f32 v119, v119
    v_exp_f32 v120, v120
    v_exp_f32 v121, v121
    v_exp_f32 v122, v122
    v_exp_f32 v123, v123
    v_smfmac_f32_32x32x32_bf16 v[168:183], v[76:79], v[108:115], v11
    v_exp_f32 v124, v124
    v_exp_f32 v125, v125
    v_exp_f32 v126, v126
    v_smfmac_f32_32x32x32_bf16 v[168:183], v[80:83], v[116:123], v11
    s_mov_b32 m0, s37
    v_exp_f32 v127, v127
    v_exp_f32 v128, v128
    v_exp_f32 v129, v129
    v_mfma_f32_32x32x4_2b_bf16 v[92:123], v[72:73], v[52:53], 0
    v_exp_f32 v130, v130
    v_exp_f32 v131, v131
    v_exp_f32 v132, v132
    v_exp_f32 v133, v133
    v_exp_f32 v134, v134
    v_exp_f32 v135, v135
    v_exp_f32 v136, v136
    v_exp_f32 v137, v137
    v_exp_f32 v138, v138
    v_exp_f32 v139, v139
    v_smfmac_f32_32x32x32_bf16 v[180:195], v[76:79], v[124:131], v11
    buffer_load_dwordx4 v0, s[16:19], s36 offen lds
    v_exp_f32 v140, v140
    v_exp_f32 v141, v141
    v_exp_f32 v142, v142
    v_smfmac_f32_32x32x32_bf16 v[180:195], v[80:83], v[132:139], v11
    s_add_u32 m0, s37, s3
    s_add_u32 s36, s36, s45
    v_exp_f32 v143, v143
    v_exp_f32 v144, v144
    v_exp_f32 v145, v145
    v_mfma_f32_32x32x16_bf16 v[92:107], v[64:67], v[32:35], v[92:107]
    buffer_load_dwordx4 v2, s[16:19], s36 offen lds
    v_exp_f32 v146, v146
    v_exp_f32 v147, v147
    v_exp_f32 v148, v148
    v_mfma_f32_32x32x16_bf16 v[108:123], v[64:67], v[36:39], v[108:123]
    v_exp_f32 v149, v149
    v_exp_f32 v150, v150
    v_exp_f32 v151, v151
    v_exp_f32 v152, v152
    v_exp_f32 v153, v153
    v_exp_f32 v154, v154
    v_exp_f32 v155, v155
    v_smfmac_f32_32x32x32_bf16 v[192:207], v[76:79], v[140:147], v11
    s_and_b32 s32, s26, 3
    s_xor_b32 s30, s32, 2
    v_exp_f32 v92, v92
    v_exp_f32 v93, v93
    v_exp_f32 v94, v94
    v_smfmac_f32_32x32x32_bf16 v[192:207], v[80:83], v[148:155], v11
    s_xor_b32 s31, s32, 3
    s_mul_i32 s30, s30, 12288
    v_exp_f32 v95, v95
    v_exp_f32 v96, v96
    v_exp_f32 v97, v97
    v_mfma_f32_32x32x4_2b_bf16 v[124:155], v[72:73], v[54:55], 0
    s_mul_i32 s31, s31, 12288
    v_exp_f32 v98, v98
    v_exp_f32 v99, v99
    v_exp_f32 v100, v100
    v_exp_f32 v101, v101
    v_exp_f32 v102, v102
    v_exp_f32 v103, v103
    v_exp_f32 v104, v104
    v_exp_f32 v105, v105
    v_exp_f32 v106, v106
    v_exp_f32 v107, v107
    v_smfmac_f32_32x32x32_bf16 v[204:219], v[76:79], v[92:99], v11
    s_add_u32 s39, s30, 103424
    s_add_u32 s33, s31, 103424
    v_exp_f32 v108, v108
    v_exp_f32 v109, v109
    v_exp_f32 v110, v110
    v_smfmac_f32_32x32x32_bf16 v[204:219], v[80:83], v[100:107], v11
    s_mov_b32 s32, 0x30800000
    s_mov_b32 s31, 0x5d800000
    v_exp_f32 v111, v111
    v_exp_f32 v112, v112
    v_exp_f32 v113, v113
    v_mfma_f32_32x32x16_bf16 v[124:139], v[64:67], v[40:43], v[124:139]
    v_exp_f32 v114, v114
    v_exp_f32 v115, v115
    v_exp_f32 v116, v116
    v_mfma_f32_32x32x16_bf16 v[140:155], v[64:67], v[44:47], v[140:155]
    v_exp_f32 v117, v117
    v_exp_f32 v118, v118
    v_exp_f32 v119, v119
    v_exp_f32 v120, v120
    v_exp_f32 v121, v121
    v_exp_f32 v122, v122
    v_exp_f32 v123, v123
    v_smfmac_f32_32x32x32_bf16 v[216:231], v[76:79], v[108:115], v11
    s_waitcnt vmcnt(4)
    v_exp_f32 v124, v124
    v_exp_f32 v125, v125
    v_exp_f32 v126, v126
    v_smfmac_f32_32x32x32_bf16 v[216:231], v[80:83], v[116:123], v11
    v_exp_f32 v127, v127
    v_exp_f32 v128, v128
    v_exp_f32 v129, v129
    v_mfma_f32_32x32x4_2b_bf16 v[92:123], v[74:75], v[48:49], 0
    v_exp_f32 v130, v130
    v_exp_f32 v131, v131
    v_exp_f32 v132, v132
    v_exp_f32 v133, v133
    v_exp_f32 v134, v134
    v_exp_f32 v135, v135
    v_exp_f32 v136, v136
    v_exp_f32 v137, v137
    v_exp_f32 v138, v138
    v_exp_f32 v139, v139
    v_and_b32 v6, 3, v1
    v_lshlrev_b32 v6, 5, v6
    v_smfmac_f32_32x32x32_bf16 v[228:243], v[76:79], v[124:131], v11
    ds_read_b32 v5, v6 offset:12
    s_lshl_b32 s30, s29, 1
    v_exp_f32 v140, v140
    v_exp_f32 v141, v141
    v_exp_f32 v142, v142
    v_smfmac_f32_32x32x32_bf16 v[228:243], v[80:83], v[132:139], v11
    v_exp_f32 v143, v143
    v_exp_f32 v144, v144
    v_exp_f32 v145, v145
    v_mfma_f32_32x32x16_bf16 v[92:107], v[68:71], v[16:19], v[92:107]
    v_exp_f32 v146, v146
    v_exp_f32 v147, v147
    v_exp_f32 v148, v148
    v_mfma_f32_32x32x16_bf16 v[108:123], v[68:71], v[20:23], v[108:123]
    v_exp_f32 v149, v149
    v_exp_f32 v150, v150
    v_exp_f32 v151, v151
    v_exp_f32 v152, v152
    v_exp_f32 v153, v153
    v_exp_f32 v154, v154
    v_exp_f32 v155, v155
    v_smfmac_f32_32x32x32_bf16 v[240:255], v[76:79], v[140:147], v11
    v_exp_f32 v92, v92
    v_exp_f32 v93, v93
    v_exp_f32 v94, v94
    v_smfmac_f32_32x32x32_bf16 v[240:255], v[80:83], v[148:155], v11
    s_waitcnt vmcnt(0)
    v_exp_f32 v95, v95
    v_exp_f32 v96, v96
    v_exp_f32 v97, v97
    v_mfma_f32_32x32x4_2b_bf16 v[124:155], v[74:75], v[50:51], 0
    v_exp_f32 v98, v98
    v_exp_f32 v99, v99
    v_exp_f32 v100, v100
    v_exp_f32 v101, v101
    v_exp_f32 v102, v102
    v_exp_f32 v103, v103
    v_exp_f32 v104, v104
    v_exp_f32 v105, v105
    v_exp_f32 v106, v106
    v_exp_f32 v107, v107
    s_waitcnt lgkmcnt(0)
    v_cmp_le_u32 vcc, s30, v5
    s_cmp_eq_u64 vcc, -1
    s_cbranch_scc0 L_afree0
L_afree_back:
    v_add_u32 v6, s39, v13
    v_add_u32 v7, s33, v13
    v_mov_b32 v5, 1
    v_xor_b32 v4, 64, v3
    s_mov_b32 s38, 0
    v_smfmac_f32_32x32x32_bf16 v[156:171], v[84:87], v[92:99], v11
    v_exp_f32 v108, v108
    v_exp_f32 v109, v109
    v_exp_f32 v110, v110
    v_smfmac_f32_32x32x32_bf16 v[156:171], v[88:91], v[100:107], v11
    v_exp_f32 v111, v111
    v_exp_f32 v112, v112
    v_exp_f32 v113, v113
    v_mfma_f32_32x32x16_bf16 v[124:139], v[68:71], v[24:27], v[124:139]
    v_exp_f32 v114, v114
    v_exp_f32 v115, v115
    v_exp_f32 v116, v116
    v_mfma_f32_32x32x16_bf16 v[140:155], v[68:71], v[28:31], v[140:155]
    v_exp_f32 v117, v117
    v_exp_f32 v118, v118
    v_exp_f32 v119, v119
    v_exp_f32 v120, v120
    v_exp_f32 v121, v121
    v_exp_f32 v122, v122
    v_exp_f32 v123, v123
    v_smfmac_f32_32x32x32_bf16 v[168:183], v[84:87], v[108:115], v11
    ds_write_b128 v15, v[156:159] offset:0
    v_exp_f32 v124, v124
    v_exp_f32 v125, v125
    v_exp_f32 v126, v126
    v_smfmac_f32_32x32x32_bf16 v[168:183], v[88:91], v[116:123], v11
    ds_write_b128 v15, v[160:163] offset:1024
    v_exp_f32 v127, v127
    v_exp_f32 v128, v128
    v_exp_f32 v129, v129
    v_mfma_f32_32x32x4_2b_bf16 v[92:123], v[74:75], v[52:53], 0
    ds_write_b128 v15, v[164:167] offset:2048
    v_exp_f32 v130, v130
    v_exp_f32 v131, v131
    v_exp_f32 v132, v132
    v_exp_f32 v133, v133
    v_exp_f32 v134, v134
    v_exp_f32 v135, v135
    v_exp_f32 v136, v136
    v_exp_f32 v137, v137
    v_exp_f32 v138, v138
    v_exp_f32 v139, v139
    v_smfmac_f32_32x32x32_bf16 v[180:195], v[84:87], v[124:131], v11
    ds_write_b128 v15, v[168:171] offset:3072
    v_exp_f32 v140, v140
    v_exp_f32 v141, v141
    v_exp_f32 v142, v142
    v_smfmac_f32_32x32x32_bf16 v[180:195], v[88:91], v[132:139], v11
    ds_write_b128 v15, v[172:175] offset:4096
    v_exp_f32 v143, v143
    v_exp_f32 v144, v144
    v_exp_f32 v145, v145
    v_mfma_f32_32x32x16_bf16 v[92:107], v[68:71], v[32:35], v[92:107]
    ds_write_b128 v15, v[176:179] offset:5120
    v_exp_f32 v146, v146
    v_exp_f32 v147, v147
    v_exp_f32 v148, v148
    v_mfma_f32_32x32x16_bf16 v[108:123], v[68:71], v[36:39], v[108:123]
    v_exp_f32 v149, v149
    v_exp_f32 v150, v150
    v_exp_f32 v151, v151
    v_exp_f32 v152, v152
    v_exp_f32 v153, v153
    v_exp_f32 v154, v154
    v_exp_f32 v155, v155
    v_smfmac_f32_32x32x32_bf16 v[192:207], v[84:87], v[140:147], v11
    ds_write_b128 v15, v[180:183] offset:6144
    v_exp_f32 v92, v92
    v_exp_f32 v93, v93
    v_exp_f32 v94, v94
    v_smfmac_f32_32x32x32_bf16 v[192:207], v[88:91], v[148:155], v11
    ds_write_b128 v15, v[184:187] offset:7168
    v_exp_f32 v95, v95
    v_exp_f32 v96, v96
    v_exp_f32 v97, v97
    v_mfma_f32_32x32x4_2b_bf16 v[124:155], v[74:75], v[54:55], 0
    ds_write_b128 v15, v[188:191] offset:8192
    v_exp_f32 v98, v98
    v_exp_f32 v99, v99
    v_exp_f32 v100, v100
    v_exp_f32 v101, v101
    v_exp_f32 v102, v102
    v_exp_f32 v103, v103
    v_exp_f32 v104, v104
    v_exp_f32 v105, v105
    v_exp_f32 v106, v106
    v_exp_f32 v107, v107
    v_smfmac_f32_32x32x32_bf16 v[204:219], v[84:87], v[92:99], v11
    ds_write_b128 v15, v[192:195] offset:9216
    v_exp_f32 v108, v108
    v_exp_f32 v109, v109
    v_exp_f32 v110, v110
    v_smfmac_f32_32x32x32_bf16 v[204:219], v[88:91], v[100:107], v11
    ds_write_b128 v15, v[196:199] offset:10240
    v_exp_f32 v111, v111
    v_exp_f32 v112, v112
    v_exp_f32 v113, v113
    v_mfma_f32_32x32x16_bf16 v[124:139], v[68:71], v[40:43], v[124:139]
    ds_write_b128 v15, v[200:203] offset:11264
    ds_write_b32 v4, v5
    v_exp_f32 v114, v114
    v_exp_f32 v115, v115
    v_exp_f32 v116, v116
    v_mfma_f32_32x32x16_bf16 v[140:155], v[68:71], v[44:47], v[140:155]
    v_exp_f32 v117, v117
    v_exp_f32 v118, v118
    v_exp_f32 v119, v119
    v_exp_f32 v120, v120
    v_exp_f32 v121, v121
    v_exp_f32 v122, v122
    v_exp_f32 v123, v123
    v_smfmac_f32_32x32x32_bf16 v[216:231], v[84:87], v[108:115], v11
    v_exp_f32 v124, v124
    v_exp_f32 v125, v125
    v_exp_f32 v126, v126
    v_smfmac_f32_32x32x32_bf16 v[216:231], v[88:91], v[116:123], v11
    ds_read_b32 v4, v3 offset:0
    ds_read_b128 v[156:159], v6 offset:0
    ds_read_b128 v[160:163], v6 offset:1024
    ds_read_b128 v[164:167], v6 offset:2048
    ds_read_b128 v[168:171], v6 offset:3072
    ds_read_b128 v[172:175], v6 offset:4096
    ds_read_b128 v[176:179], v6 offset:5120
    v_exp_f32 v127, v127
    v_exp_f32 v128, v128
    v_exp_f32 v129, v129
    ds_read_b128 v[180:183], v6 offset:6144
    ds_read_b128 v[184:187], v6 offset:7168
    ds_read_b128 v[188:191], v6 offset:8192
    ds_read_b128 v[192:195], v6 offset:9216
    ds_read_b128 v[196:199], v6 offset:10240
    ds_read_b128 v[200:203], v6 offset:11264
    v_exp_f32 v130, v130
    v_exp_f32 v131, v131
    v_exp_f32 v132, v132
    v_exp_f32 v133, v133
    v_exp_f32 v134, v134
    v_exp_f32 v135, v135
    v_exp_f32 v136, v136
    v_exp_f32 v137, v137
    v_exp_f32 v138, v138
    v_exp_f32 v139, v139
    v_smfmac_f32_32x32x32_bf16 v[228:243], v[84:87], v[124:131], v11
    v_exp_f32 v140, v140
    v_exp_f32 v141, v141
    v_exp_f32 v142, v142
    v_smfmac_f32_32x32x32_bf16 v[228:243], v[88:91], v[132:139], v11
    v_exp_f32 v143, v143
    v_exp_f32 v144, v144
    v_exp_f32 v145, v145
    v_exp_f32 v146, v146
    v_exp_f32 v147, v147
    s_waitcnt lgkmcnt(12)
    v_readfirstlane_b32 s30, v4
    s_cmp_eq_u32 s30, 0
    s_cbranch_scc1 L_cmb_w
L_cmb_ok:
    s_waitcnt lgkmcnt(6)
    v_pk_add_f32 v[204:205], v[204:205], v[156:157]
    v_pk_add_f32 v[206:207], v[206:207], v[158:159]
    v_pk_add_f32 v[208:209], v[208:209], v[160:161]
    v_pk_add_f32 v[210:211], v[210:211], v[162:163]
    v_pk_add_f32 v[212:213], v[212:213], v[164:165]
    v_pk_add_f32 v[214:215], v[214:215], v[166:167]
    v_pk_add_f32 v[216:217], v[216:217], v[168:169]
    v_pk_add_f32 v[218:219], v[218:219], v[170:171]
    v_pk_add_f32 v[220:221], v[220:221], v[172:173]
    v_pk_add_f32 v[222:223], v[222:223], v[174:175]
    v_pk_add_f32 v[224:225], v[224:225], v[176:177]
    v_pk_add_f32 v[226:227], v[226:227], v[178:179]
    ds_write_b128 v6, v[204:207] offset:0
    ds_write_b128 v6, v[208:211] offset:1024
    ds_write_b128 v6, v[212:215] offset:2048
    ds_write_b128 v6, v[216:219] offset:3072
    ds_write_b128 v6, v[220:223] offset:4096
    ds_write_b128 v6, v[224:227] offset:5120
    v_xor_b32 v4, 32, v3
    ds_write_b32 v4, v5 offset:4
    v_exp_f32 v148, v148
    v_exp_f32 v149, v149
    v_exp_f32 v150, v150
    v_exp_f32 v151, v151
    v_exp_f32 v152, v152
    v_exp_f32 v153, v153
    v_exp_f32 v154, v154
    v_exp_f32 v155, v155
    ds_read_b32 v4, v3 offset:4
    ds_read_b128 v[92:95], v7 offset:0
    v_smfmac_f32_32x32x32_bf16 v[240:255], v[84:87], v[140:147], v11
    v_smfmac_f32_32x32x32_bf16 v[240:255], v[88:91], v[148:155], v11
    ds_read_b128 v[96:99], v7 offset:1024
    ds_read_b128 v[100:103], v7 offset:2048
    ds_read_b128 v[104:107], v7 offset:3072
    ds_read_b128 v[108:111], v7 offset:4096
    ds_read_b128 v[112:115], v7 offset:5120
    s_waitcnt lgkmcnt(14)
    v_pk_add_f32 v[228:229], v[228:229], v[180:181]
    v_pk_add_f32 v[230:231], v[230:231], v[182:183]
    v_pk_add_f32 v[232:233], v[232:233], v[184:185]
    v_pk_add_f32 v[234:235], v[234:235], v[186:187]
    v_pk_add_f32 v[236:237], v[236:237], v[188:189]
    v_pk_add_f32 v[238:239], v[238:239], v[190:191]
    s_mov_b32 s38, 0
    s_waitcnt lgkmcnt(6)
    v_readfirstlane_b32 s30, v4
    s_cmp_eq_u32 s30, 0
    s_cbranch_scc1 L_cmb2_w
L_cmb2_ok:
    s_waitcnt lgkmcnt(3)
    v_pk_add_f32 v[228:229], v[228:229], v[92:93]
    v_pk_add_f32 v[230:231], v[230:231], v[94:95]
    v_pk_add_f32 v[232:233], v[232:233], v[96:97]
    v_pk_add_f32 v[234:235], v[234:235], v[98:99]
    v_pk_add_f32 v[236:237], v[236:237], v[100:101]
    v_pk_add_f32 v[238:239], v[238:239], v[102:103]
    v_pk_add_f32 v[240:241], v[240:241], v[192:193]
    v_pk_add_f32 v[242:243], v[242:243], v[194:195]
    v_pk_add_f32 v[244:245], v[244:245], v[196:197]
    v_pk_add_f32 v[246:247], v[246:247], v[198:199]
    v_pk_add_f32 v[248:249], v[248:249], v[200:201]
    v_pk_add_f32 v[250:251], v[250:251], v[202:203]
    s_waitcnt lgkmcnt(0)
    v_pk_add_f32 v[240:241], v[240:241], v[104:105]
    v_pk_add_f32 v[242:243], v[242:243], v[106:107]
    v_pk_add_f32 v[244:245], v[244:245], v[108:109]
    v_pk_add_f32 v[246:247], v[246:247], v[110:111]
    v_pk_add_f32 v[248:249], v[248:249], v[112:113]
    v_pk_add_f32 v[250:251], v[250:251], v[114:115]
    v_mov_b32 v128, v236
    v_mov_b32 v129, v236
    v_mov_b32 v130, v248
    v_mov_b32 v131, v248
    s_mov_b32 s35, 1
    v_mov_b32 v5, 2
    v_permlane32_swap_b32 v129, v128
    v_permlane32_swap_b32 v131, v130
L_fin:
    v_rcp_f32 v124, v128
    v_rcp_f32 v126, v130
    s_nop 0
    v_pk_mul_f32 v[228:229], v[228:229], v[124:125] op_sel_hi:[1,0]
    v_pk_mul_f32 v[230:231], v[230:231], v[124:125] op_sel_hi:[1,0]
    v_pk_mul_f32 v[232:233], v[232:233], v[124:125] op_sel_hi:[1,0]
    v_pk_mul_f32 v[234:235], v[234:235], v[124:125] op_sel_hi:[1,0]
    v_pk_mul_f32 v[236:237], v[236:237], v[124:125] op_sel_hi:[1,0]
    v_pk_mul_f32 v[238:239], v[238:239], v[124:125] op_sel_hi:[1,0]
    v_cvt_pk_bf16_f32 v92, v228, v229
    v_cvt_pk_bf16_f32 v93, v230, v231
    v_cvt_pk_bf16_f32 v94, v232, v233
    v_cvt_pk_bf16_f32 v95, v234, v235
    buffer_store_dwordx4 v[92:95], v13, s[8:11], s53 offen offset:0 sc1
    v_cvt_pk_bf16_f32 v100, v236, v237
    v_cvt_pk_bf16_f32 v101, v238, v239
    v_pk_mul_f32 v[240:241], v[240:241], v[126:127] op_sel_hi:[1,0]
    v_pk_mul_f32 v[242:243], v[242:243], v[126:127] op_sel_hi:[1,0]
    v_pk_mul_f32 v[244:245], v[244:245], v[126:127] op_sel_hi:[1,0]
    v_pk_mul_f32 v[246:247], v[246:247], v[126:127] op_sel_hi:[1,0]
    v_pk_mul_f32 v[248:249], v[248:249], v[126:127] op_sel_hi:[1,0]
    v_pk_mul_f32 v[250:251], v[250:251], v[126:127] op_sel_hi:[1,0]
    v_cvt_pk_bf16_f32 v96, v240, v241
    v_cvt_pk_bf16_f32 v97, v242, v243
    v_cvt_pk_bf16_f32 v98, v244, v245
    v_cvt_pk_bf16_f32 v99, v246, v247
    buffer_store_dwordx4 v[96:99], v13, s[8:11], s53 offen offset:1024 sc1
    v_cvt_pk_bf16_f32 v102, v248, v249
    v_cvt_pk_bf16_f32 v103, v250, v251
    buffer_store_dwordx4 v[100:103], v14, s[8:11], s53 offen sc1
    ds_write_b32 v3, v5 offset:12
    s_cmp_eq_u32 s35, 0
    s_cbranch_scc1 L_guard_ok
    v_pk_mul_f32 v[124:125], v[228:229], 0
    v_pk_mul_f32 v[126:127], v[240:241], 0
    v_pk_fma_f32 v[124:125], v[230:231], 0, v[124:125]
    v_pk_fma_f32 v[126:127], v[242:243], 0, v[126:127]
    v_pk_fma_f32 v[124:125], v[232:233], 0, v[124:125]
    v_pk_fma_f32 v[126:127], v[244:245], 0, v[126:127]
    v_pk_fma_f32 v[124:125], v[234:235], 0, v[124:125]
    v_pk_fma_f32 v[126:127], v[246:247], 0, v[126:127]
    v_pk_fma_f32 v[124:125], v[236:237], 0, v[124:125]
    v_pk_fma_f32 v[126:127], v[248:249], 0, v[126:127]
    v_pk_fma_f32 v[124:125], v[238:239], 0, v[124:125]
    v_pk_fma_f32 v[126:127], v[250:251], 0, v[126:127]
    v_cmp_le_f32 s[46:47], s32, v128
    v_cmp_le_f32 s[48:49], s32, v130
    v_pk_add_f32 v[124:125], v[124:125], v[126:127]
    v_cmp_ge_f32 vcc, s31, v128
    s_and_b64 s[46:47], s[46:47], s[48:49]
    v_cmp_ge_f32 s[48:49], s31, v130
    s_and_b64 s[46:47], s[46:47], vcc
    v_cmp_o_f32 vcc, v124, v125
    s_and_b64 s[46:47], s[46:47], s[48:49]
    s_and_b64 s[46:47], s[46:47], vcc
    s_cmp_eq_u64 s[46:47], -1
    s_cbranch_scc0 L_slow
L_guard_ok:
    v_mov_b32 v252, s20
    v_mov_b32 v253, s21
    v_lshrrev_b32 v7, 4, v1
    v_and_b32 v6, 15, v1
    s_lshl_b32 s30, s27, 8
    v_lshl_add_u32 v4, v6, 4, s30
    v_lshrrev_b32 v5, 5, v1
    v_mul_u32_u24 v5, 2560, v5
    v_and_b32 v8, 16, v1
    v_lshl_add_u32 v8, v8, 5, v5
    v_add_u32 v8, v8, v4
    v_mul_u32_u24 v9, 5120, v7
    v_add_u32 v9, v9, v4
    v_add_u32 v9, 2048, v9
    s_mul_i32 s30, s29, 40960
    s_add_u32 s30, s30, 1024
    v_and_b32 v4, 31, v1
    v_mul_u32_u24 v4, 40, v4
    v_add3_u32 v10, v4, v5, s30
    s_mul_i32 s30, s29, 35840
    s_sub_u32 s30, 81920, s30
    v_add_u32 v11, s30, v10
    v_and_b32 v5, 4, v6
    v_lshlrev_b32 v5, 1, v5
    v_and_b32 v4, 8, v6
    v_lshrrev_b32 v4, 1, v4
    v_and_b32 v6, 3, v6
    v_or3_b32 v5, v5, v6, v4
    v_mul_u32_u24 v5, 176, v5
    v_mad_u32_u24 v0, v7, 40, v5
    s_and_b32 s30, s26, 3
    s_mul_i32 s30, s30, 12288
    s_add_u32 s39, s30, 103424
    v_add_u32 v0, s39, v0
    s_lshl_b32 s30, s25, 3
    s_lshl_b32 s42, 0xff, s30
    s_waitcnt vmcnt(0)
    s_mov_b64 exec, 1
    buffer_atomic_swap_x2 v[252:253], off, s[8:11], s54 sc1
    s_mov_b64 exec, -1
    s_cmp_eq_u32 s29, 0
    s_cbranch_scc1 L_aload
    v_and_b32 v6, 7, v1
    v_lshlrev_b32 v6, 5, v6
    s_mov_b32 s38, 0
L_wdoneB:
    ds_read_b32 v5, v6 offset:12
    s_add_u32 s38, s38, 1
    s_waitcnt lgkmcnt(0)
    v_cmp_le_u32 vcc, 2, v5
    s_cmp_gt_u32 s38, 0x20000
    s_cbranch_scc1 L_wdoneB_ok
    s_cmp_eq_u64 vcc, -1
    s_cbranch_scc1 L_wdoneB_ok
    s_sleep 2
    s_branch L_wdoneB
L_wdoneB_ok:
    s_mov_b32 s38, 0
    v_mov_b32 v4, 0
    v_mov_b32 v5, 0
    buffer_atomic_or_x2 v[4:5], v12, s[8:11], s41 offen sc0 sc1
L_poll2:
    s_add_u32 s38, s38, 1
    s_waitcnt vmcnt(0)
L_poll2e:
    v_cmp_eq_u64 vcc, s[20:21], v[4:5]
    s_cmp_gt_u32 s38, 0x8000
    s_cbranch_scc1 L_first
    s_or_b32 s30, vcc_lo, s42
    s_andn2_b32 s30, 0xffff, s30
    s_cbranch_scc0 L_first
    s_xor_b32 s42, s42, 0xffff
    s_or_b32 s30, vcc_lo, s42
    s_andn2_b32 s30, 0xffff, s30
    s_cbranch_scc0 L_first
    s_sleep 2
    v_mov_b32 v4, 0
    v_mov_b32 v5, 0
    buffer_atomic_or_x2 v[4:5], v12, s[8:11], s41 offen sc0 sc1
    s_branch L_poll2
L_first:
    s_andn2_b32 s30, s42, vcc_lo
    s_cbranch_scc0 L_norp
    v_mov_b32 v4, 0
    v_mov_b32 v5, 0
    buffer_atomic_or_x2 v[4:5], v12, s[8:11], s41 offen sc0 sc1
L_norp:
    s_lshr_b32 s30, s42, 15
    s_xor_b32 s31, s30, 1
    s_mul_i32 s36, s30, 20480
    s_add_u32 s36, s36, s40
    s_mul_i32 s32, s31, 20480
    s_add_u32 s40, s40, s32
    s_add_u32 s33, s40, 0
    buffer_load_dwordx4 v[96:99], v8, s[8:11], s33 offen offset:0 sc1
    buffer_load_dwordx4 v[100:103], v8, s[8:11], s33 offen offset:1024 sc1
    s_add_u32 s33, s40, 5120
    buffer_load_dwordx4 v[104:107], v8, s[8:11], s33 offen offset:0 sc1
    buffer_load_dwordx4 v[108:111], v8, s[8:11], s33 offen offset:1024 sc1
    s_add_u32 s33, s40, 10240
    buffer_load_dwordx4 v[112:115], v8, s[8:11], s33 offen offset:0 sc1
    buffer_load_dwordx4 v[116:119], v8, s[8:11], s33 offen offset:1024 sc1
    s_add_u32 s33, s40, 15360
    buffer_load_dwordx4 v[120:123], v8, s[8:11], s33 offen offset:0 sc1
    buffer_load_dwordx4 v[124:127], v8, s[8:11], s33 offen offset:1024 sc1
    buffer_load_dwordx4 v[128:131], v9, s[8:11], s40 offen offset:0 sc1
    buffer_load_dwordx4 v[132:135], v9, s[8:11], s40 offen offset:2560 sc1
    s_mul_i32 s30, s30, 10240
    s_mul_i32 s31, s31, 10240
    v_add_u32 v13, s30, v11
    v_add_u32 v11, s31, v11
    v_lshl_add_u32 v2, s30, 1, v10
    v_lshl_add_u32 v10, s31, 1, v10
    ds_read_b64_tr_b16 v[56:57], v10 offset:0
    ds_read_b64_tr_b16 v[58:59], v10 offset:1280
    ds_read_b64_tr_b16 v[60:61], v10 offset:8
    ds_read_b64_tr_b16 v[62:63], v10 offset:1288
    ds_read_b64_tr_b16 v[64:65], v10 offset:16
    ds_read_b64_tr_b16 v[66:67], v10 offset:1296
    ds_read_b64_tr_b16 v[68:69], v10 offset:24
    ds_read_b64_tr_b16 v[70:71], v10 offset:1304
    ds_read_b64_tr_b16 v[72:73], v10 offset:32
    ds_read_b64_tr_b16 v[74:75], v10 offset:1312
    s_waitcnt vmcnt(10)
L_chk2:
    v_cmp_eq_u64 vcc, s[20:21], v[4:5]
    s_andn2_b32 s37, s42, vcc_lo
    s_cbranch_scc1 L_more
    s_add_u32 s33, s36, 0
    buffer_load_dwordx4 v[136:139], v8, s[8:11], s33 offen offset:0 sc1
    buffer_load_dwordx4 v[140:143], v8, s[8:11], s33 offen offset:1024 sc1
    s_add_u32 s33, s36, 5120
    buffer_load_dwordx4 v[144:147], v8, s[8:11], s33 offen offset:0 sc1
    buffer_load_dwordx4 v[148:151], v8, s[8:11], s33 offen offset:1024 sc1
    s_add_u32 s33, s36, 10240
    buffer_load_dwordx4 v[152:155], v8, s[8:11], s33 offen offset:0 sc1
    buffer_load_dwordx4 v[156:159], v8, s[8:11], s33 offen offset:1024 sc1
    s_add_u32 s33, s36, 15360
    buffer_load_dwordx4 v[160:163], v8, s[8:11], s33 offen offset:0 sc1
    buffer_load_dwordx4 v[164:167], v8, s[8:11], s33 offen offset:1024 sc1
    buffer_load_dwordx4 v[168:171], v9, s[8:11], s36 offen offset:0 sc1
    buffer_load_dwordx4 v[172:175], v9, s[8:11], s36 offen offset:2560 sc1
L_aback:
    s_cmp_eq_u32 s37, 0
    s_cbranch_scc1 L_both0
    s_waitcnt vmcnt(8)
L_both0:
    s_waitcnt vmcnt(18) lgkmcnt(0)
    v_mfma_f32_16x16x32_bf16 v[16:19], v[56:59], v[96:99], 0
    ds_read_b64_tr_b16 v[76:77], v10 offset:5120
    ds_read_b64_tr_b16 v[78:79], v10 offset:6400
    v_mfma_f32_16x16x32_bf16 v[20:23], v[60:63], v[96:99], 0
    ds_read_b64_tr_b16 v[80:81], v10 offset:5128
    ds_read_b64_tr_b16 v[82:83], v10 offset:6408
    v_mfma_f32_16x16x32_bf16 v[24:27], v[64:67], v[96:99], 0
    ds_read_b64_tr_b16 v[84:85], v10 offset:5136
    ds_read_b64_tr_b16 v[86:87], v10 offset:6416
    v_mfma_f32_16x16x32_bf16 v[28:31], v[68:71], v[96:99], 0
    ds_read_b64_tr_b16 v[88:89], v10 offset:5144
    ds_read_b64_tr_b16 v[90:91], v10 offset:6424
    v_mfma_f32_16x16x32_bf16 v[32:35], v[72:75], v[96:99], 0
    ds_read_b64_tr_b16 v[92:93], v10 offset:5152
    ds_read_b64_tr_b16 v[94:95], v10 offset:6432
    v_mfma_f32_16x16x32_bf16 v[36:39], v[56:59], v[100:103], 0
    v_mfma_f32_16x16x32_bf16 v[40:43], v[60:63], v[100:103], 0
    v_mfma_f32_16x16x32_bf16 v[44:47], v[64:67], v[100:103], 0
    v_mfma_f32_16x16x32_bf16 v[48:51], v[68:71], v[100:103], 0
    v_mfma_f32_16x16x32_bf16 v[52:55], v[72:75], v[100:103], 0
    s_cmp_eq_u32 s37, 0
    s_cbranch_scc1 L_both1
    s_waitcnt vmcnt(6)
L_both1:
    s_waitcnt vmcnt(16) lgkmcnt(0)
    v_mfma_f32_16x16x32_bf16 v[16:19], v[76:79], v[104:107], v[16:19]
    ds_read_b64_tr_b16 v[56:57], v10 offset:10240
    ds_read_b64_tr_b16 v[58:59], v10 offset:11520
    v_mfma_f32_16x16x32_bf16 v[20:23], v[80:83], v[104:107], v[20:23]
    ds_read_b64_tr_b16 v[60:61], v10 offset:10248
    ds_read_b64_tr_b16 v[62:63], v10 offset:11528
    v_mfma_f32_16x16x32_bf16 v[24:27], v[84:87], v[104:107], v[24:27]
    ds_read_b64_tr_b16 v[64:65], v10 offset:10256
    ds_read_b64_tr_b16 v[66:67], v10 offset:11536
    v_mfma_f32_16x16x32_bf16 v[28:31], v[88:91], v[104:107], v[28:31]
    ds_read_b64_tr_b16 v[68:69], v10 offset:10264
    ds_read_b64_tr_b16 v[70:71], v10 offset:11544
    v_mfma_f32_16x16x32_bf16 v[32:35], v[92:95], v[104:107], v[32:35]
    ds_read_b64_tr_b16 v[72:73], v10 offset:10272
    ds_read_b64_tr_b16 v[74:75], v10 offset:11552
    v_mfma_f32_16x16x32_bf16 v[36:39], v[76:79], v[108:111], v[36:39]
    v_mfma_f32_16x16x32_bf16 v[40:43], v[80:83], v[108:111], v[40:43]
    v_mfma_f32_16x16x32_bf16 v[44:47], v[84:87], v[108:111], v[44:47]
    v_mfma_f32_16x16x32_bf16 v[48:51], v[88:91], v[108:111], v[48:51]
    v_mfma_f32_16x16x32_bf16 v[52:55], v[92:95], v[108:111], v[52:55]
    s_cmp_eq_u32 s37, 0
    s_cbranch_scc1 L_both2
    v_mov_b32 v4, 0
    v_mov_b32 v5, 0
    buffer_atomic_or_x2 v[4:5], v12, s[8:11], s41 offen sc0 sc1
    s_waitcnt vmcnt(5)
L_both2:
    s_waitcnt vmcnt(14) lgkmcnt(0)
    v_mfma_f32_16x16x32_bf16 v[16:19], v[56:59], v[112:115], v[16:19]
    ds_read_b64_tr_b16 v[76:77], v10 offset:15360
    ds_read_b64_tr_b16 v[78:79], v10 offset:16640
    v_mfma_f32_16x16x32_bf16 v[20:23], v[60:63], v[112:115], v[20:23]
    ds_read_b64_tr_b16 v[80:81], v10 offset:15368
    ds_read_b64_tr_b16 v[82:83], v10 offset:16648
    v_mfma_f32_16x16x32_bf16 v[24:27], v[64:67], v[112:115], v[24:27]
    ds_read_b64_tr_b16 v[84:85], v10 offset:15376
    ds_read_b64_tr_b16 v[86:87], v10 offset:16656
    v_mfma_f32_16x16x32_bf16 v[28:31], v[68:71], v[112:115], v[28:31]
    ds_read_b64_tr_b16 v[88:89], v10 offset:15384
    ds_read_b64_tr_b16 v[90:91], v10 offset:16664
    v_mfma_f32_16x16x32_bf16 v[32:35], v[72:75], v[112:115], v[32:35]
    ds_read_b64_tr_b16 v[92:93], v10 offset:15392
    ds_read_b64_tr_b16 v[94:95], v10 offset:16672
    v_mfma_f32_16x16x32_bf16 v[36:39], v[56:59], v[116:119], v[36:39]
    v_mfma_f32_16x16x32_bf16 v[40:43], v[60:63], v[116:119], v[40:43]
    v_mfma_f32_16x16x32_bf16 v[44:47], v[64:67], v[116:119], v[44:47]
    v_mfma_f32_16x16x32_bf16 v[48:51], v[68:71], v[116:119], v[48:51]
    v_mfma_f32_16x16x32_bf16 v[52:55], v[72:75], v[116:119], v[52:55]
    s_cmp_eq_u32 s37, 0
    s_cbranch_scc1 L_both3
    s_waitcnt vmcnt(3)
L_both3:
    s_waitcnt vmcnt(12) lgkmcnt(0)
    v_mfma_f32_16x16x32_bf16 v[16:19], v[76:79], v[120:123], v[16:19]
    ds_read_b64_tr_b16 v[56:57], v11 offset:0
    ds_read_b64_tr_b16 v[58:59], v11 offset:1280
    v_mfma_f32_16x16x32_bf16 v[20:23], v[80:83], v[120:123], v[20:23]
    ds_read_b64_tr_b16 v[60:61], v11 offset:8
    ds_read_b64_tr_b16 v[62:63], v11 offset:1288
    v_mfma_f32_16x16x32_bf16 v[24:27], v[84:87], v[120:123], v[24:27]
    ds_read_b64_tr_b16 v[64:65], v11 offset:16
    ds_read_b64_tr_b16 v[66:67], v11 offset:1296
    v_mfma_f32_16x16x32_bf16 v[28:31], v[88:91], v[120:123], v[28:31]
    ds_read_b64_tr_b16 v[68:69], v11 offset:24
    ds_read_b64_tr_b16 v[70:71], v11 offset:1304
    v_mfma_f32_16x16x32_bf16 v[32:35], v[92:95], v[120:123], v[32:35]
    ds_read_b64_tr_b16 v[72:73], v11 offset:32
    ds_read_b64_tr_b16 v[74:75], v11 offset:1312
    v_mfma_f32_16x16x32_bf16 v[36:39], v[76:79], v[124:127], v[36:39]
    v_mfma_f32_16x16x32_bf16 v[40:43], v[80:83], v[124:127], v[40:43]
    v_mfma_f32_16x16x32_bf16 v[44:47], v[84:87], v[124:127], v[44:47]
    v_mfma_f32_16x16x32_bf16 v[48:51], v[88:91], v[124:127], v[48:51]
    v_mfma_f32_16x16x32_bf16 v[52:55], v[92:95], v[124:127], v[52:55]
    s_cmp_eq_u32 s37, 0
    s_cbranch_scc1 L_both4
    s_waitcnt vmcnt(1)
L_both4:
    s_waitcnt vmcnt(10) lgkmcnt(0)
    v_swap_b32 v130, v132
    v_swap_b32 v131, v133
    s_nop 1
    v_mfma_f32_16x16x32_bf16 v[16:19], v[56:59], v[128:131], v[16:19]
    ds_read_b64_tr_b16 v[76:77], v2 offset:0
    ds_read_b64_tr_b16 v[78:79], v2 offset:1280
    v_mfma_f32_16x16x32_bf16 v[20:23], v[60:63], v[128:131], v[20:23]
    ds_read_b64_tr_b16 v[80:81], v2 offset:8
    ds_read_b64_tr_b16 v[82:83], v2 offset:1288
    v_mfma_f32_16x16x32_bf16 v[24:27], v[64:67], v[128:131], v[24:27]
    ds_read_b64_tr_b16 v[84:85], v2 offset:16
    ds_read_b64_tr_b16 v[86:87], v2 offset:1296
    v_mfma_f32_16x16x32_bf16 v[28:31], v[68:71], v[128:131], v[28:31]
    ds_read_b64_tr_b16 v[88:89], v2 offset:24
    ds_read_b64_tr_b16 v[90:91], v2 offset:1304
    v_mfma_f32_16x16x32_bf16 v[32:35], v[72:75], v[128:131], v[32:35]
    ds_read_b64_tr_b16 v[92:93], v2 offset:32
    ds_read_b64_tr_b16 v[94:95], v2 offset:1312
    v_mfma_f32_16x16x32_bf16 v[36:39], v[56:59], v[132:135], v[36:39]
    v_mfma_f32_16x16x32_bf16 v[40:43], v[60:63], v[132:135], v[40:43]
    v_mfma_f32_16x16x32_bf16 v[44:47], v[64:67], v[132:135], v[44:47]
    v_mfma_f32_16x16x32_bf16 v[48:51], v[68:71], v[132:135], v[48:51]
    v_mfma_f32_16x16x32_bf16 v[52:55], v[72:75], v[132:135], v[52:55]
    s_cmp_eq_u32 s37, 0
    s_cbranch_scc0 L_second
L_both5:
    s_waitcnt vmcnt(8) lgkmcnt(0)
    v_mfma_f32_16x16x32_bf16 v[216:219], v[76:79], v[136:139], 0
    ds_read_b64_tr_b16 v[56:57], v2 offset:5120
    ds_read_b64_tr_b16 v[58:59], v2 offset:6400
    v_mfma_f32_16x16x32_bf16 v[220:223], v[80:83], v[136:139], 0
    ds_read_b64_tr_b16 v[60:61], v2 offset:5128
    ds_read_b64_tr_b16 v[62:63], v2 offset:6408
    v_mfma_f32_16x16x32_bf16 v[224:227], v[84:87], v[136:139], 0
    ds_read_b64_tr_b16 v[64:65], v2 offset:5136
    ds_read_b64_tr_b16 v[66:67], v2 offset:6416
    v_mfma_f32_16x16x32_bf16 v[228:231], v[88:91], v[136:139], 0
    ds_read_b64_tr_b16 v[68:69], v2 offset:5144
    ds_read_b64_tr_b16 v[70:71], v2 offset:6424
    v_mfma_f32_16x16x32_bf16 v[232:235], v[92:95], v[136:139], 0
    ds_read_b64_tr_b16 v[72:73], v2 offset:5152
    ds_read_b64_tr_b16 v[74:75], v2 offset:6432
    v_mfma_f32_16x16x32_bf16 v[236:239], v[76:79], v[140:143], 0
    v_mfma_f32_16x16x32_bf16 v[240:243], v[80:83], v[140:143], 0
    v_mfma_f32_16x16x32_bf16 v[244:247], v[84:87], v[140:143], 0
    v_mfma_f32_16x16x32_bf16 v[248:251], v[88:91], v[140:143], 0
    v_mfma_f32_16x16x32_bf16 v[252:255], v[92:95], v[140:143], 0
    s_waitcnt vmcnt(6) lgkmcnt(0)
    v_mfma_f32_16x16x32_bf16 v[216:219], v[56:59], v[144:147], v[216:219]
    ds_read_b64_tr_b16 v[76:77], v2 offset:10240
    ds_read_b64_tr_b16 v[78:79], v2 offset:11520
    v_mfma_f32_16x16x32_bf16 v[220:223], v[60:63], v[144:147], v[220:223]
    ds_read_b64_tr_b16 v[80:81], v2 offset:10248
    ds_read_b64_tr_b16 v[82:83], v2 offset:11528
    v_mfma_f32_16x16x32_bf16 v[224:227], v[64:67], v[144:147], v[224:227]
    ds_read_b64_tr_b16 v[84:85], v2 offset:10256
    ds_read_b64_tr_b16 v[86:87], v2 offset:11536
    v_mfma_f32_16x16x32_bf16 v[228:231], v[68:71], v[144:147], v[228:231]
    ds_read_b64_tr_b16 v[88:89], v2 offset:10264
    ds_read_b64_tr_b16 v[90:91], v2 offset:11544
    v_mfma_f32_16x16x32_bf16 v[232:235], v[72:75], v[144:147], v[232:235]
    ds_read_b64_tr_b16 v[92:93], v2 offset:10272
    ds_read_b64_tr_b16 v[94:95], v2 offset:11552
    v_mfma_f32_16x16x32_bf16 v[236:239], v[56:59], v[148:151], v[236:239]
    v_mfma_f32_16x16x32_bf16 v[240:243], v[60:63], v[148:151], v[240:243]
    v_mfma_f32_16x16x32_bf16 v[244:247], v[64:67], v[148:151], v[244:247]
    v_mfma_f32_16x16x32_bf16 v[248:251], v[68:71], v[148:151], v[248:251]
    v_mfma_f32_16x16x32_bf16 v[252:255], v[72:75], v[148:151], v[252:255]
    s_waitcnt vmcnt(4) lgkmcnt(0)
    v_mfma_f32_16x16x32_bf16 v[216:219], v[76:79], v[152:155], v[216:219]
    ds_read_b64_tr_b16 v[56:57], v2 offset:15360
    ds_read_b64_tr_b16 v[58:59], v2 offset:16640
    v_mfma_f32_16x16x32_bf16 v[220:223], v[80:83], v[152:155], v[220:223]
    ds_read_b64_tr_b16 v[60:61], v2 offset:15368
    ds_read_b64_tr_b16 v[62:63], v2 offset:16648
    v_mfma_f32_16x16x32_bf16 v[224:227], v[84:87], v[152:155], v[224:227]
    ds_read_b64_tr_b16 v[64:65], v2 offset:15376
    ds_read_b64_tr_b16 v[66:67], v2 offset:16656
    v_mfma_f32_16x16x32_bf16 v[228:231], v[88:91], v[152:155], v[228:231]
    ds_read_b64_tr_b16 v[68:69], v2 offset:15384
    ds_read_b64_tr_b16 v[70:71], v2 offset:16664
    v_mfma_f32_16x16x32_bf16 v[232:235], v[92:95], v[152:155], v[232:235]
    ds_read_b64_tr_b16 v[72:73], v2 offset:15392
    ds_read_b64_tr_b16 v[74:75], v2 offset:16672
    v_mfma_f32_16x16x32_bf16 v[236:239], v[76:79], v[156:159], v[236:239]
    v_lshrrev_b32 v100, 3, v1
    v_and_b32 v101, 7, v1
    v_mfma_f32_16x16x32_bf16 v[240:243], v[80:83], v[156:159], v[240:243]
    v_mul_u32_u24 v96, 176, v100
    v_mul_u32_u24 v97, 2560, v100
    v_mfma_f32_16x16x32_bf16 v[244:247], v[84:87], v[156:159], v[244:247]
    v_lshl_add_u32 v96, v101, 4, v96
    v_lshl_add_u32 v97, v101, 4, v97
    v_mfma_f32_16x16x32_bf16 v[248:251], v[88:91], v[156:159], v[248:251]
    v_add_u32 v96, s39, v96
    v_lshrrev_b32 v100, 1, v1
    v_mfma_f32_16x16x32_bf16 v[252:255], v[92:95], v[156:159], v[252:255]
    v_and_b32 v101, 1, v1
    v_mul_u32_u24 v98, 176, v100
    s_waitcnt vmcnt(2) lgkmcnt(0)
    v_mfma_f32_16x16x32_bf16 v[216:219], v[56:59], v[160:163], v[216:219]
    ds_read_b64_tr_b16 v[76:77], v13 offset:0
    ds_read_b64_tr_b16 v[78:79], v13 offset:1280
    v_mfma_f32_16x16x32_bf16 v[220:223], v[60:63], v[160:163], v[220:223]
    ds_read_b64_tr_b16 v[80:81], v13 offset:8
    ds_read_b64_tr_b16 v[82:83], v13 offset:1288
    v_mfma_f32_16x16x32_bf16 v[224:227], v[64:67], v[160:163], v[224:227]
    ds_read_b64_tr_b16 v[84:85], v13 offset:16
    ds_read_b64_tr_b16 v[86:87], v13 offset:1296
    v_mfma_f32_16x16x32_bf16 v[228:231], v[68:71], v[160:163], v[228:231]
    ds_read_b64_tr_b16 v[88:89], v13 offset:24
    ds_read_b64_tr_b16 v[90:91], v13 offset:1304
    v_mfma_f32_16x16x32_bf16 v[232:235], v[72:75], v[160:163], v[232:235]
    ds_read_b64_tr_b16 v[92:93], v13 offset:32
    ds_read_b64_tr_b16 v[94:95], v13 offset:1312
    v_mfma_f32_16x16x32_bf16 v[236:239], v[56:59], v[164:167], v[236:239]
    v_and_b32 v102, 24, v100
    v_add_u32 v100, v100, v102
    v_mfma_f32_16x16x32_bf16 v[240:243], v[60:63], v[164:167], v[240:243]
    v_mul_u32_u24 v99, 2560, v100
    v_lshl_add_u32 v98, v101, 4, v98
    v_mfma_f32_16x16x32_bf16 v[244:247], v[64:67], v[164:167], v[244:247]
    v_lshl_add_u32 v99, v101, 4, v99
    v_add_u32 v98, s39, v98
    v_mfma_f32_16x16x32_bf16 v[248:251], v[68:71], v[164:167], v[248:251]
    v_mfma_f32_16x16x32_bf16 v[252:255], v[72:75], v[164:167], v[252:255]
    s_waitcnt vmcnt(0) lgkmcnt(0)
    v_swap_b32 v170, v172
    v_swap_b32 v171, v173
    s_nop 1
    v_mfma_f32_16x16x32_bf16 v[216:219], v[76:79], v[168:171], v[216:219]
    ds_read_b32 v4, v3 offset:8
    ds_read_b128 v[176:179], v15 offset:0
    v_mfma_f32_16x16x32_bf16 v[220:223], v[80:83], v[168:171], v[220:223]
    ds_read_b128 v[180:183], v15 offset:1024
    ds_read_b128 v[184:187], v15 offset:2048
    v_mfma_f32_16x16x32_bf16 v[224:227], v[84:87], v[168:171], v[224:227]
    ds_read_b128 v[188:191], v15 offset:3072
    ds_read_b128 v[192:195], v15 offset:4096
    v_mfma_f32_16x16x32_bf16 v[228:231], v[88:91], v[168:171], v[228:231]
    ds_read_b128 v[196:199], v15 offset:5120
    ds_read_b128 v[200:203], v15 offset:6144
    v_mfma_f32_16x16x32_bf16 v[232:235], v[92:95], v[168:171], v[232:235]
    ds_read_b128 v[204:207], v15 offset:7168
    ds_read_b128 v[208:211], v15 offset:8192
    v_mfma_f32_16x16x32_bf16 v[236:239], v[76:79], v[172:175], v[236:239]
    ds_read_b128 v[212:215], v15 offset:9216
    v_mfma_f32_16x16x32_bf16 v[240:243], v[80:83], v[172:175], v[240:243]
    v_mfma_f32_16x16x32_bf16 v[244:247], v[84:87], v[172:175], v[244:247]
    v_mfma_f32_16x16x32_bf16 v[248:251], v[88:91], v[172:175], v[248:251]
    v_mfma_f32_16x16x32_bf16 v[252:255], v[92:95], v[172:175], v[252:255]
    s_mov_b32 s38, 0
    s_add_u32 s31, s51, 81920
    v_mov_b32 v5, 1
    s_cmp_eq_u32 s29, 0
    s_cbranch_scc0 L_x1
    v_add_f32 v16, v16, v216
    v_add_f32 v17, v17, v217
    v_add_f32 v18, v18, v218
    v_add_f32 v19, v19, v219
    ds_write_b128 v15, v[16:19] offset:0
    v_add_f32 v20, v20, v220
    v_add_f32 v21, v21, v221
    v_add_f32 v22, v22, v222
    v_add_f32 v23, v23, v223
    ds_write_b128 v15, v[20:23] offset:1024
    v_add_f32 v24, v24, v224
    v_add_f32 v25, v25, v225
    v_add_f32 v26, v26, v226
    v_add_f32 v27, v27, v227
    ds_write_b128 v15, v[24:27] offset:2048
    v_add_f32 v28, v28, v228
    v_add_f32 v29, v29, v229
    v_add_f32 v30, v30, v230
    v_add_f32 v31, v31, v231
    ds_write_b128 v15, v[28:31] offset:3072
    v_add_f32 v32, v32, v232
    v_add_f32 v33, v33, v233
    v_add_f32 v34, v34, v234
    v_add_f32 v35, v35, v235
    ds_write_b128 v15, v[32:35] offset:4096
    v_add_f32 v36, v36, v236
    v_add_f32 v37, v37, v237
    v_add_f32 v38, v38, v238
    v_add_f32 v39, v39, v239
    ds_write_b128 v15, v[36:39] offset:5120
    v_add_f32 v40, v40, v240
    v_add_f32 v41, v41, v241
    v_add_f32 v42, v42, v242
    v_add_f32 v43, v43, v243
    ds_write_b128 v15, v[40:43] offset:6144
    v_add_f32 v44, v44, v244
    v_add_f32 v45, v45, v245
    v_add_f32 v46, v46, v246
    v_add_f32 v47, v47, v247
    ds_write_b128 v15, v[44:47] offset:7168
    v_add_f32 v48, v48, v248
    v_add_f32 v49, v49, v249
    v_add_f32 v50, v50, v250
    v_add_f32 v51, v51, v251
    ds_write_b128 v15, v[48:51] offset:8192
    v_add_f32 v52, v52, v252
    v_add_f32 v53, v53, v253
    v_add_f32 v54, v54, v254
    v_add_f32 v55, v55, v255
    ds_write_b128 v15, v[52:55] offset:9216
    ds_write_b32 v3, v5 offset:136
    s_waitcnt lgkmcnt(0)
    s_endpgm
L_x1:
    s_waitcnt lgkmcnt(10)
    v_readfirstlane_b32 s30, v4
    s_cmp_eq_u32 s30, 0
    s_cbranch_scc1 L_xch_w
L_xch_ok:
    v_pk_add_f32 v[16:17], v[16:17], v[216:217]
    v_pk_add_f32 v[18:19], v[18:19], v[218:219]
    v_pk_add_f32 v[20:21], v[20:21], v[220:221]
    v_pk_add_f32 v[22:23], v[22:23], v[222:223]
    v_pk_add_f32 v[24:25], v[24:25], v[224:225]
    v_pk_add_f32 v[26:27], v[26:27], v[226:227]
    v_pk_add_f32 v[28:29], v[28:29], v[228:229]
    v_pk_add_f32 v[30:31], v[30:31], v[230:231]
    v_pk_add_f32 v[32:33], v[32:33], v[232:233]
    v_pk_add_f32 v[34:35], v[34:35], v[234:235]
    v_pk_add_f32 v[36:37], v[36:37], v[236:237]
    v_pk_add_f32 v[38:39], v[38:39], v[238:239]
    v_pk_add_f32 v[40:41], v[40:41], v[240:241]
    v_pk_add_f32 v[42:43], v[42:43], v[242:243]
    v_pk_add_f32 v[44:45], v[44:45], v[244:245]
    v_pk_add_f32 v[46:47], v[46:47], v[246:247]
    v_pk_add_f32 v[48:49], v[48:49], v[248:249]
    v_pk_add_f32 v[50:51], v[50:51], v[250:251]
    v_pk_add_f32 v[52:53], v[52:53], v[252:253]
    v_pk_add_f32 v[54:55], v[54:55], v[254:255]
    s_waitcnt lgkmcnt(0)
    v_pk_add_f32 v[16:17], v[16:17], v[176:177]
    v_pk_add_f32 v[18:19], v[18:19], v[178:179]
    v_cvt_pk_bf16_f32 v56, v16, v17
    v_cvt_pk_bf16_f32 v57, v18, v19
    ds_write_b64 v0, v[56:57] offset:0
    v_pk_add_f32 v[20:21], v[20:21], v[180:181]
    v_pk_add_f32 v[22:23], v[22:23], v[182:183]
    v_cvt_pk_bf16_f32 v58, v20, v21
    v_cvt_pk_bf16_f32 v59, v22, v23
    ds_write_b64 v0, v[58:59] offset:8
    v_pk_add_f32 v[24:25], v[24:25], v[184:185]
    v_pk_add_f32 v[26:27], v[26:27], v[186:187]
    v_cvt_pk_bf16_f32 v60, v24, v25
    v_cvt_pk_bf16_f32 v61, v26, v27
    ds_write_b64 v0, v[60:61] offset:16
    v_pk_add_f32 v[28:29], v[28:29], v[188:189]
    v_pk_add_f32 v[30:31], v[30:31], v[190:191]
    v_cvt_pk_bf16_f32 v62, v28, v29
    v_cvt_pk_bf16_f32 v63, v30, v31
    ds_write_b64 v0, v[62:63] offset:24
    v_pk_add_f32 v[32:33], v[32:33], v[192:193]
    v_pk_add_f32 v[34:35], v[34:35], v[194:195]
    v_cvt_pk_bf16_f32 v64, v32, v33
    v_cvt_pk_bf16_f32 v65, v34, v35
    ds_write_b64 v0, v[64:65] offset:32
    ds_read_b128 v[104:107], v96 offset:0
    ds_read_b128 v[108:111], v96 offset:1408
    v_pk_add_f32 v[36:37], v[36:37], v[196:197]
    v_pk_add_f32 v[38:39], v[38:39], v[198:199]
    v_cvt_pk_bf16_f32 v68, v36, v37
    v_cvt_pk_bf16_f32 v69, v38, v39
    ds_write_b64 v0, v[68:69] offset:2816
    v_pk_add_f32 v[40:41], v[40:41], v[200:201]
    v_pk_add_f32 v[42:43], v[42:43], v[202:203]
    v_cvt_pk_bf16_f32 v70, v40, v41
    v_cvt_pk_bf16_f32 v71, v42, v43
    ds_write_b64 v0, v[70:71] offset:2824
    v_pk_add_f32 v[44:45], v[44:45], v[204:205]
    v_pk_add_f32 v[46:47], v[46:47], v[206:207]
    v_cvt_pk_bf16_f32 v72, v44, v45
    v_cvt_pk_bf16_f32 v73, v46, v47
    ds_write_b64 v0, v[72:73] offset:2832
    v_pk_add_f32 v[48:49], v[48:49], v[208:209]
    v_pk_add_f32 v[50:51], v[50:51], v[210:211]
    v_cvt_pk_bf16_f32 v74, v48, v49
    v_cvt_pk_bf16_f32 v75, v50, v51
    ds_write_b64 v0, v[74:75] offset:2840
    v_pk_add_f32 v[52:53], v[52:53], v[212:213]
    v_pk_add_f32 v[54:55], v[54:55], v[214:215]
    v_cvt_pk_bf16_f32 v76, v52, v53
    v_cvt_pk_bf16_f32 v77, v54, v55
    ds_write_b64 v0, v[76:77] offset:2848
    ds_read_b128 v[112:115], v96 offset:2816
    ds_read_b128 v[116:119], v96 offset:4224
    ds_read_b128 v[120:123], v98 offset:128
    s_add_u32 s31, s51, 0
    s_waitcnt lgkmcnt(9)
    buffer_store_dwordx4 v[104:107], v97, s[12:15], s31 offen
    s_add_u32 s31, s51, 40960
    s_waitcnt lgkmcnt(8)
    buffer_store_dwordx4 v[108:111], v97, s[12:15], s31 offen
    s_add_u32 s31, s51, 81920
    s_waitcnt lgkmcnt(2)
    buffer_store_dwordx4 v[112:115], v97, s[12:15], s31 offen
    s_add_u32 s31, s51, 122880
    s_waitcnt lgkmcnt(1)
    buffer_store_dwordx4 v[116:119], v97, s[12:15], s31 offen
    s_waitcnt lgkmcnt(0)
    buffer_store_dwordx4 v[120:123], v99, s[12:15], s51 offen offset:128
L_xdone:
L_exit:
L_end:
    s_endpgm
L_mid:
    s_add_u32 s43, s43, 1
    s_cmp_eq_u32 s35, 3
    s_cbranch_scc0 L_mid2
    s_lshl_b32 s32, s23, 1
    s_add_u32 s32, s32, s25
    s_lshl_b32 s32, s32, 1
    s_add_u32 s32, s32, s28
    s_lshl_b32 s31, s22, 5
    s_add_u32 s31, s31, s32
    s_lshl_b32 s31, s31, 1
    s_add_u32 s31, s31, s29
    s_mul_i32 s40, s31, 40960
    s_add_u32 s40, s40, 12582912
    s_mul_i32 s31, s31, 8576
    s_add_u32 s41, s31, 18923520
    s_lshl_b32 s32, s32, 3
    s_add_u32 s32, s32, s27
    s_mul_i32 s51, s32, 20480
    s_mul_i32 s31, s22, 1280
    s_add_u32 s51, s51, s31
    s_and_b32 s31, s24, 7
    s_mul_i32 s31, s31, 160
    s_add_u32 s51, s51, s31
    s_cmp_eq_u32 s55, 0
    s_cbranch_scc1 L_poll3_ok
    s_mov_b32 s38, 0
L_poll3:
    v_mov_b32 v4, 0
    v_mov_b32 v5, 0
    buffer_atomic_or_x2 v[4:5], v12, s[8:11], s52 offen sc0 sc1
    s_add_u32 s38, s38, 1
    s_waitcnt vmcnt(0)
    v_cmp_eq_u64 vcc, s[20:21], v[4:5]
    s_cmp_gt_u32 s38, 0x4000
    s_cbranch_scc1 L_poll3_ok
    s_andn2_b32 s30, 0xffff, vcc_lo
    s_cbranch_scc0 L_poll3_ok
    s_sleep 2
    s_branch L_poll3
L_poll3_ok:
L_mid2:
    s_cmp_eq_u32 s29, 0
    s_cselect_b32 s43, 0, s43
    s_cbranch_scc1 L_attn_go
    s_cmp_eq_u32 s35, 4
    s_cbranch_scc0 L_mid3
    s_setprio 1
L_mid3:
    s_cmp_ge_u32 s35, 4
    s_cselect_b32 s43, 0, s43
    s_cmp_eq_u32 s35, 4
    s_cbranch_scc0 L_attn_go
    s_cmp_lt_u32 s26, 5
    s_cbranch_scc1 L_attn_go
    v_mov_b32 v0, 2.0
    v_mov_b32 v2, 2.0
    s_mov_b32 s37, 160768
    s_mov_b32 s44, 0
    s_mov_b32 s42, 0
    s_mov_b32 s34, 0
    s_mov_b32 s36, 0
    s_branch L_attn_go
L_more:
    ds_read_b32 v6, v3 offset:8
    s_add_u32 s38, s38, 1
    s_waitcnt lgkmcnt(0)
    v_readfirstlane_b32 s30, v6
    s_cmp_gt_u32 s38, 0x8000
    s_cbranch_scc1 L_aback
    s_cmp_eq_u32 s30, 0
    s_cbranch_scc0 L_aback
    v_mov_b32 v4, 0
    v_mov_b32 v5, 0
    buffer_atomic_or_x2 v[4:5], v12, s[8:11], s41 offen sc0 sc1
    s_waitcnt vmcnt(0)
    s_branch L_chk2
L_second:
    s_waitcnt vmcnt(0)
    v_cmp_eq_u64 vcc, s[20:21], v[4:5]
    s_andn2_b32 s30, s42, vcc_lo
    s_cbranch_scc0 L_poll5_ok
    s_mov_b32 s38, 0
L_poll5:
    v_mov_b32 v4, 0
    v_mov_b32 v5, 0
    buffer_atomic_or_x2 v[4:5], v12, s[8:11], s41 offen sc0 sc1
    s_add_u32 s38, s38, 1
    s_waitcnt vmcnt(0)
    v_cmp_eq_u64 vcc, s[20:21], v[4:5]
    s_cmp_gt_u32 s38, 0x8000
    s_cbranch_scc1 L_poll5_ok
    s_andn2_b32 s30, s42, vcc_lo
    s_cbranch_scc0 L_poll5_ok
    s_sleep 2
    s_branch L_poll5
L_poll5_ok:
    s_add_u32 s33, s36, 0
    buffer_load_dwordx4 v[136:139], v8, s[8:11], s33 offen offset:0 sc1
    buffer_load_dwordx4 v[140:143], v8, s[8:11], s33 offen offset:1024 sc1
    s_add_u32 s33, s36, 5120
    buffer_load_dwordx4 v[144:147], v8, s[8:11], s33 offen offset:0 sc1
    buffer_load_dwordx4 v[148:151], v8, s[8:11], s33 offen offset:1024 sc1
    s_add_u32 s33, s36, 10240
    buffer_load_dwordx4 v[152:155], v8, s[8:11], s33 offen offset:0 sc1
    buffer_load_dwordx4 v[156:159], v8, s[8:11], s33 offen offset:1024 sc1
    s_add_u32 s33, s36, 15360
    buffer_load_dwordx4 v[160:163], v8, s[8:11], s33 offen offset:0 sc1
    buffer_load_dwordx4 v[164:167], v8, s[8:11], s33 offen offset:1024 sc1
    buffer_load_dwordx4 v[168:171], v9, s[8:11], s36 offen offset:0 sc1
    buffer_load_dwordx4 v[172:175], v9, s[8:11], s36 offen offset:2560 sc1
    s_branch L_both5
L_aload:
    s_waitcnt vmcnt(0)
    s_mov_b32 s38, 0
L_poll4:
    v_mov_b32 v4, 0
    v_mov_b32 v5, 0
    buffer_atomic_or_x2 v[4:5], v12, s[8:11], s41 offen sc0 sc1
    s_add_u32 s38, s38, 1
    s_waitcnt vmcnt(0)
    v_cmp_eq_u64 vcc, s[20:21], v[4:5]
    s_cmp_gt_u32 s38, 0x8000
    s_cbranch_scc1 L_poll4_ok
    s_andn2_b32 s30, 0xffff, vcc_lo
    s_cbranch_scc0 L_poll4_ok
    s_sleep 2
    s_branch L_poll4
L_poll4_ok:
    s_lshr_b32 s30, s42, 15
    s_xor_b32 s31, s30, 1
    s_mul_i32 s36, s30, 20480
    s_add_u32 s36, s36, s40
    s_mul_i32 s32, s31, 20480
    s_add_u32 s40, s40, s32
    s_mul_i32 s30, s30, 10240
    s_mul_i32 s31, s31, 10240
    v_add_u32 v13, s30, v11
    v_add_u32 v11, s31, v11
    v_lshl_add_u32 v2, s30, 1, v10
    v_lshl_add_u32 v10, s31, 1, v10
    s_mov_b32 s37, 0
    s_add_u32 s33, s40, 0
    buffer_load_dwordx4 v[96:99], v8, s[8:11], s33 offen offset:0 sc1
    buffer_load_dwordx4 v[100:103], v8, s[8:11], s33 offen offset:1024 sc1
    s_waitcnt vmcnt(4)
    s_add_u32 s33, s40, 5120
    buffer_load_dwordx4 v[104:107], v8, s[8:11], s33 offen offset:0 sc1
    buffer_load_dwordx4 v[108:111], v8, s[8:11], s33 offen offset:1024 sc1
    s_waitcnt vmcnt(4)
    s_add_u32 s33, s40, 10240
    buffer_load_dwordx4 v[112:115], v8, s[8:11], s33 offen offset:0 sc1
    buffer_load_dwordx4 v[116:119], v8, s[8:11], s33 offen offset:1024 sc1
    s_waitcnt vmcnt(4)
    s_add_u32 s33, s40, 15360
    buffer_load_dwordx4 v[120:123], v8, s[8:11], s33 offen offset:0 sc1
    buffer_load_dwordx4 v[124:127], v8, s[8:11], s33 offen offset:1024 sc1
    s_waitcnt vmcnt(4)
    buffer_load_dwordx4 v[128:131], v9, s[8:11], s40 offen offset:0 sc1
    buffer_load_dwordx4 v[132:135], v9, s[8:11], s40 offen offset:2560 sc1
    s_waitcnt vmcnt(4)
    s_add_u32 s33, s36, 0
    buffer_load_dwordx4 v[136:139], v8, s[8:11], s33 offen offset:0 sc1
    buffer_load_dwordx4 v[140:143], v8, s[8:11], s33 offen offset:1024 sc1
    s_waitcnt vmcnt(4)
    s_add_u32 s33, s36, 5120
    buffer_load_dwordx4 v[144:147], v8, s[8:11], s33 offen offset:0 sc1
    buffer_load_dwordx4 v[148:151], v8, s[8:11], s33 offen offset:1024 sc1
    s_waitcnt vmcnt(4)
    s_add_u32 s33, s36, 10240
    buffer_load_dwordx4 v[152:155], v8, s[8:11], s33 offen offset:0 sc1
    buffer_load_dwordx4 v[156:159], v8, s[8:11], s33 offen offset:1024 sc1
    s_waitcnt vmcnt(4)
    s_add_u32 s33, s36, 15360
    buffer_load_dwordx4 v[160:163], v8, s[8:11], s33 offen offset:0 sc1
    buffer_load_dwordx4 v[164:167], v8, s[8:11], s33 offen offset:1024 sc1
    s_waitcnt vmcnt(4)
    buffer_load_dwordx4 v[168:171], v9, s[8:11], s36 offen offset:0 sc1
    buffer_load_dwordx4 v[172:175], v9, s[8:11], s36 offen offset:2560 sc1
    s_waitcnt vmcnt(4)
    s_setprio 0
    v_and_b32 v6, 7, v1
    v_lshlrev_b32 v6, 5, v6
    s_mov_b32 s38, 0
L_wdone:
    ds_read_b32 v5, v6 offset:12
    s_add_u32 s38, s38, 1
    s_waitcnt lgkmcnt(0)
    v_cmp_le_u32 vcc, 2, v5
    s_cmp_gt_u32 s38, 0x20000
    s_cbranch_scc1 L_wdone_ok
    s_cmp_eq_u64 vcc, -1
    s_cbranch_scc1 L_wdone_ok
    s_sleep 2
    s_branch L_wdone
L_wdone_ok:
    s_setprio 2
    ds_read_b64_tr_b16 v[56:57], v10 offset:0
    ds_read_b64_tr_b16 v[58:59], v10 offset:1280
    ds_read_b64_tr_b16 v[60:61], v10 offset:8
    ds_read_b64_tr_b16 v[62:63], v10 offset:1288
    ds_read_b64_tr_b16 v[64:65], v10 offset:16
    ds_read_b64_tr_b16 v[66:67], v10 offset:1296
    ds_read_b64_tr_b16 v[68:69], v10 offset:24
    ds_read_b64_tr_b16 v[70:71], v10 offset:1304
    ds_read_b64_tr_b16 v[72:73], v10 offset:32
    ds_read_b64_tr_b16 v[74:75], v10 offset:1312
    s_branch L_aback
L_nonce0:
    s_mov_b32 s30, 0
L_nonce_retry0:
    v_mov_b32 v4, 0
    global_load_dwordx2 v[252:253], v4, s[44:45] sc0 sc1
    s_add_u32 s30, s30, 1
    s_waitcnt vmcnt(0)
    v_readfirstlane_b32 s21, v253
    v_readfirstlane_b32 s20, v252
    s_cmp_gt_u32 s30, 0x4000
    s_cbranch_scc1 L_nonce_ok0
    s_cmp_eq_u32 s21, 0
    s_cbranch_scc1 L_nonce_retry0
    s_branch L_nonce_ok0
L_nonce1:
    s_mov_b32 s30, 0
L_nonce_retry1:
    v_mov_b32 v4, 0
    global_load_dwordx2 v[252:253], v4, s[44:45] sc0 sc1
    s_add_u32 s30, s30, 1
    s_waitcnt vmcnt(0)
    v_readfirstlane_b32 s21, v253
    v_readfirstlane_b32 s20, v252
    s_cmp_gt_u32 s30, 0x4000
    s_cbranch_scc1 L_nonce_ok1
    s_cmp_eq_u32 s21, 0
    s_cbranch_scc1 L_nonce_retry1
    s_branch L_nonce_ok1
L_afree0:
    v_and_b32 v6, 3, v1
    v_lshlrev_b32 v6, 5, v6
    s_mov_b32 s38, 0
L_afree:
    ds_read_b32 v5, v6 offset:12
    s_add_u32 s38, s38, 1
    s_waitcnt lgkmcnt(0)
    v_cmp_le_u32 vcc, 2, v5
    s_cmp_gt_u32 s38, 0x20000
    s_cbranch_scc1 L_afree_ok
    s_cmp_eq_u64 vcc, -1
    s_cbranch_scc1 L_afree_ok
    s_sleep 2
    s_branch L_afree
L_afree_ok:
    s_branch L_afree_back
L_cmb_w:
    s_add_u32 s38, s38, 1
    s_cmp_gt_u32 s38, 0x20000
    s_cbranch_scc1 L_cmb_ok
    s_sleep 1
    ds_read_b32 v4, v3 offset:0
    s_waitcnt lgkmcnt(0)
    v_readfirstlane_b32 s30, v4
    s_cmp_eq_u32 s30, 0
    s_cbranch_scc1 L_cmb_w
    s_branch L_cmb
L_cmb:
    ds_read_b128 v[156:159], v6 offset:0
    ds_read_b128 v[160:163], v6 offset:1024
    ds_read_b128 v[164:167], v6 offset:2048
    ds_read_b128 v[168:171], v6 offset:3072
    ds_read_b128 v[172:175], v6 offset:4096
    ds_read_b128 v[176:179], v6 offset:5120
    ds_read_b128 v[180:183], v6 offset:6144
    ds_read_b128 v[184:187], v6 offset:7168
    ds_read_b128 v[188:191], v6 offset:8192
    ds_read_b128 v[192:195], v6 offset:9216
    ds_read_b128 v[196:199], v6 offset:10240
    ds_read_b128 v[200:203], v6 offset:11264
    s_branch L_cmb_ok
L_cmb2_w:
    s_add_u32 s38, s38, 1
    s_cmp_gt_u32 s38, 0x20000
    s_cbranch_scc1 L_cmb2_ok
    s_sleep 1
    ds_read_b32 v4, v3 offset:4
    s_waitcnt lgkmcnt(0)
    v_readfirstlane_b32 s30, v4
    s_cmp_eq_u32 s30, 0
    s_cbranch_scc1 L_cmb2_w
    s_branch L_cmb2
L_cmb2:
    ds_read_b128 v[92:95], v7 offset:0
    ds_read_b128 v[96:99], v7 offset:1024
    ds_read_b128 v[100:103], v7 offset:2048
    ds_read_b128 v[104:107], v7 offset:3072
    ds_read_b128 v[108:111], v7 offset:4096
    ds_read_b128 v[112:115], v7 offset:5120
    s_branch L_cmb2_ok
L_xch_w:
    s_add_u32 s38, s38, 1
    s_cmp_gt_u32 s38, 0x20000
    s_cbranch_scc1 L_xch_ok
    s_sleep 1
    ds_read_b32 v4, v3 offset:8
    s_waitcnt lgkmcnt(0)
    v_readfirstlane_b32 s30, v4
    s_cmp_eq_u32 s30, 0
    s_cbranch_scc1 L_xch_w
    s_branch L_xch
L_xch:
    ds_read_b128 v[176:179], v15 offset:0
    ds_read_b128 v[180:183], v15 offset:1024
    ds_read_b128 v[184:187], v15 offset:2048
    ds_read_b128 v[188:191], v15 offset:3072
    ds_read_b128 v[192:195], v15 offset:4096
    ds_read_b128 v[196:199], v15 offset:5120
    ds_read_b128 v[200:203], v15 offset:6144
    ds_read_b128 v[204:207], v15 offset:7168
    ds_read_b128 v[208:211], v15 offset:8192
    ds_read_b128 v[212:215], v15 offset:9216
    s_branch L_xch_ok
L_slow:
    s_waitcnt vmcnt(0)
    s_and_b32 s30, s26, 3
    s_mul_i32 s30, s30, 12288
    s_sub_u32 s50, s50, s30
    s_mov_b32 s39, s50
    s_add_u32 s35, s50, 393216
    v_mov_b32 v156, 0xff800000
    v_mov_b32 v157, 0xff800000
L_slow1:
    buffer_load_dwordx4 v[64:67], v8, s[8:11], s39 offen offset:0 sc1
    buffer_load_dwordx2 v[72:73], v9, s[8:11], s39 offen offset:0 sc1
    buffer_load_dwordx4 v[68:71], v8, s[8:11], s39 offen offset:2048 sc1
    buffer_load_dwordx2 v[74:75], v9, s[8:11], s39 offen offset:1024 sc1
    s_waitcnt vmcnt(0)
    v_mfma_f32_32x32x4_2b_bf16 v[124:155], v[72:73], v[54:55], 0
    s_nop 15
    s_nop 1
    v_mfma_f32_32x32x16_bf16 v[124:139], v[64:67], v[40:43], v[124:139]
    v_mfma_f32_32x32x16_bf16 v[140:155], v[64:67], v[44:47], v[140:155]
    s_nop 15
    v_max3_f32 v156, v156, v124, v125
    v_max3_f32 v156, v156, v126, v127
    v_max3_f32 v156, v156, v128, v129
    v_max3_f32 v156, v156, v130, v131
    v_max3_f32 v156, v156, v132, v133
    v_max3_f32 v156, v156, v134, v135
    v_max3_f32 v156, v156, v136, v137
    v_max3_f32 v156, v156, v138, v139
    v_max3_f32 v157, v157, v140, v141
    v_max3_f32 v157, v157, v142, v143
    v_max3_f32 v157, v157, v144, v145
    v_max3_f32 v157, v157, v146, v147
    v_max3_f32 v157, v157, v148, v149
    v_max3_f32 v157, v157, v150, v151
    v_max3_f32 v157, v157, v152, v153
    v_max3_f32 v157, v157, v154, v155
    v_mfma_f32_32x32x4_2b_bf16 v[124:155], v[74:75], v[54:55], 0
    s_nop 15
    s_nop 1
    v_mfma_f32_32x32x16_bf16 v[124:139], v[68:71], v[40:43], v[124:139]
    v_mfma_f32_32x32x16_bf16 v[140:155], v[68:71], v[44:47], v[140:155]
    s_nop 15
    v_max3_f32 v156, v156, v124, v125
    v_max3_f32 v156, v156, v126, v127
    v_max3_f32 v156, v156, v128, v129
    v_max3_f32 v156, v156, v130, v131
    v_max3_f32 v156, v156, v132, v133
    v_max3_f32 v156, v156, v134, v135
    v_max3_f32 v156, v156, v136, v137
    v_max3_f32 v156, v156, v138, v139
    v_max3_f32 v157, v157, v140, v141
    v_max3_f32 v157, v157, v142, v143
    v_max3_f32 v157, v157, v144, v145
    v_max3_f32 v157, v157, v146, v147
    v_max3_f32 v157, v157, v148, v149
    v_max3_f32 v157, v157, v150, v151
    v_max3_f32 v157, v157, v152, v153
    v_max3_f32 v157, v157, v154, v155
    s_add_u32 s39, s39, 12288
    s_cmp_lt_u32 s39, s35
    s_cbranch_scc1 L_slow1
    v_mov_b32 v4, v156
    s_nop 1
    v_permlane32_swap_b32 v4, v156
    s_nop 1
    v_max_f32 v4, v4, v156
    v_sub_f32 v92, 0, v4
    v_sub_f32 v93, 0, v4
    v_sub_f32 v94, 0, v4
    v_sub_f32 v95, 0, v4
    v_sub_f32 v96, 0, v4
    v_sub_f32 v97, 0, v4
    v_sub_f32 v98, 0, v4
    v_sub_f32 v99, 0, v4
    v_sub_f32 v100, 0, v4
    v_sub_f32 v101, 0, v4
    v_sub_f32 v102, 0, v4
    v_sub_f32 v103, 0, v4
    v_sub_f32 v104, 0, v4
    v_sub_f32 v105, 0, v4
    v_sub_f32 v106, 0, v4
    v_sub_f32 v107, 0, v4
    v_mov_b32 v4, v157
    s_nop 1
    v_permlane32_swap_b32 v4, v157
    s_nop 1
    v_max_f32 v4, v4, v157
    v_sub_f32 v108, 0, v4
    v_sub_f32 v109, 0, v4
    v_sub_f32 v110, 0, v4
    v_sub_f32 v111, 0, v4
    v_sub_f32 v112, 0, v4
    v_sub_f32 v113, 0, v4
    v_sub_f32 v114, 0, v4
    v_sub_f32 v115, 0, v4
    v_sub_f32 v116, 0, v4
    v_sub_f32 v117, 0, v4
    v_sub_f32 v118, 0, v4
    v_sub_f32 v119, 0, v4
    v_sub_f32 v120, 0, v4
    v_sub_f32 v121, 0, v4
    v_sub_f32 v122, 0, v4
    v_sub_f32 v123, 0, v4
    v_mov_b32 v228, 0
    v_mov_b32 v229, 0
    v_mov_b32 v230, 0
    v_mov_b32 v231, 0
    v_mov_b32 v232, 0
    v_mov_b32 v233, 0
    v_mov_b32 v234, 0
    v_mov_b32 v235, 0
    v_mov_b32 v236, 0
    v_mov_b32 v237, 0
    v_mov_b32 v238, 0
    v_mov_b32 v239, 0
    v_mov_b32 v240, 0
    v_mov_b32 v241, 0
    v_mov_b32 v242, 0
    v_mov_b32 v243, 0
    v_mov_b32 v244, 0
    v_mov_b32 v245, 0
    v_mov_b32 v246, 0
    v_mov_b32 v247, 0
    v_mov_b32 v248, 0
    v_mov_b32 v249, 0
    v_mov_b32 v250, 0
    v_mov_b32 v251, 0
    s_mov_b32 s39, s50
L_slow2:
    buffer_load_dwordx4 v[64:67], v8, s[8:11], s39 offen offset:0 sc1
    buffer_load_dwordx2 v[72:73], v9, s[8:11], s39 offen offset:0 sc1
    buffer_load_dwordx4 v[76:79], v10, s[8:11], s39 offen offset:0 sc1
    buffer_load_dwordx4 v[80:83], v10, s[8:11], s39 offen offset:512 sc1
    buffer_load_dwordx4 v[68:71], v8, s[8:11], s39 offen offset:2048 sc1
    buffer_load_dwordx2 v[74:75], v9, s[8:11], s39 offen offset:1024 sc1
    buffer_load_dwordx4 v[84:87], v10, s[8:11], s39 offen offset:3072 sc1
    buffer_load_dwordx4 v[88:91], v10, s[8:11], s39 offen offset:3584 sc1
    s_waitcnt vmcnt(0)
    v_mfma_f32_32x32x4_2b_bf16 v[124:155], v[72:73], v[54:55], v[92:123]
    s_nop 15
    s_nop 1
    v_mfma_f32_32x32x16_bf16 v[124:139], v[64:67], v[40:43], v[124:139]
    v_mfma_f32_32x32x16_bf16 v[140:155], v[64:67], v[44:47], v[140:155]
    s_nop 15
    v_exp_f32 v124, v124
    v_exp_f32 v125, v125
    v_exp_f32 v126, v126
    v_exp_f32 v127, v127
    v_exp_f32 v128, v128
    v_exp_f32 v129, v129
    v_exp_f32 v130, v130
    v_exp_f32 v131, v131
    v_exp_f32 v132, v132
    v_exp_f32 v133, v133
    v_exp_f32 v134, v134
    v_exp_f32 v135, v135
    v_exp_f32 v136, v136
    v_exp_f32 v137, v137
    v_exp_f32 v138, v138
    v_exp_f32 v139, v139
    v_exp_f32 v140, v140
    v_exp_f32 v141, v141
    v_exp_f32 v142, v142
    v_exp_f32 v143, v143
    v_exp_f32 v144, v144
    v_exp_f32 v145, v145
    v_exp_f32 v146, v146
    v_exp_f32 v147, v147
    v_exp_f32 v148, v148
    v_exp_f32 v149, v149
    v_exp_f32 v150, v150
    v_exp_f32 v151, v151
    v_exp_f32 v152, v152
    v_exp_f32 v153, v153
    v_exp_f32 v154, v154
    v_exp_f32 v155, v155
    s_nop 1
    v_smfmac_f32_32x32x32_bf16 v[228:243], v[76:79], v[124:131], v11
    v_smfmac_f32_32x32x32_bf16 v[228:243], v[80:83], v[132:139], v11
    s_nop 10
    v_smfmac_f32_32x32x32_bf16 v[240:255], v[76:79], v[140:147], v11
    v_smfmac_f32_32x32x32_bf16 v[240:255], v[80:83], v[148:155], v11
    v_mfma_f32_32x32x4_2b_bf16 v[124:155], v[74:75], v[54:55], v[92:123]
    s_nop 15
    s_nop 1
    v_mfma_f32_32x32x16_bf16 v[124:139], v[68:71], v[40:43], v[124:139]
    v_mfma_f32_32x32x16_bf16 v[140:155], v[68:71], v[44:47], v[140:155]
    s_nop 15
    v_exp_f32 v124, v124
    v_exp_f32 v125, v125
    v_exp_f32 v126, v126
    v_exp_f32 v127, v127
    v_exp_f32 v128, v128
    v_exp_f32 v129, v129
    v_exp_f32 v130, v130
    v_exp_f32 v131, v131
    v_exp_f32 v132, v132
    v_exp_f32 v133, v133
    v_exp_f32 v134, v134
    v_exp_f32 v135, v135
    v_exp_f32 v136, v136
    v_exp_f32 v137, v137
    v_exp_f32 v138, v138
    v_exp_f32 v139, v139
    v_exp_f32 v140, v140
    v_exp_f32 v141, v141
    v_exp_f32 v142, v142
    v_exp_f32 v143, v143
    v_exp_f32 v144, v144
    v_exp_f32 v145, v145
    v_exp_f32 v146, v146
    v_exp_f32 v147, v147
    v_exp_f32 v148, v148
    v_exp_f32 v149, v149
    v_exp_f32 v150, v150
    v_exp_f32 v151, v151
    v_exp_f32 v152, v152
    v_exp_f32 v153, v153
    v_exp_f32 v154, v154
    v_exp_f32 v155, v155
    s_nop 1
    v_smfmac_f32_32x32x32_bf16 v[228:243], v[84:87], v[124:131], v11
    v_smfmac_f32_32x32x32_bf16 v[228:243], v[88:91], v[132:139], v11
    s_nop 10
    v_smfmac_f32_32x32x32_bf16 v[240:255], v[84:87], v[140:147], v11
    v_smfmac_f32_32x32x32_bf16 v[240:255], v[88:91], v[148:155], v11
    s_add_u32 s39, s39, 12288
    s_cmp_lt_u32 s39, s35
    s_cbranch_scc1 L_slow2
    s_nop 15
    v_mov_b32 v128, v236
    v_mov_b32 v129, v236
    v_mov_b32 v130, v248
    v_mov_b32 v131, v248
    s_nop 1
    v_permlane32_swap_b32 v129, v128
    v_permlane32_swap_b32 v131, v130
    s_mov_b32 s35, 0
    s_branch L_fin
L_code_end:
.section .rodata,"a"
.p2align 6
.amdhsa_kernel concat_heads__mha_block__softmax_full_mha__prompt_kernel
  .amdhsa_next_free_vgpr 256
  .amdhsa_next_free_sgpr 102
  .amdhsa_accum_offset 256
  .amdhsa_group_segment_fixed_size 0
  .amdhsa_kernarg_size 72
  .amdhsa_user_sgpr_count 2
  .amdhsa_user_sgpr_kernarg_segment_ptr 1
  .amdhsa_system_sgpr_workgroup_id_x 1
.end_amdhsa_kernel
```
